```python
import torch

def _softmax(x, axis=-1):
    return torch.softmax(x, dim=axis)
def _gelu(x):
    return torch.nn.functional.gelu(x, approximate="tanh")
def _silu(x):
    return torch.nn.functional.silu(x)
def _sigmoid(x):
    return torch.sigmoid(x)
def _layernorm(x, axis=-1, eps=1e-5):
    m = x.mean(dim=axis, keepdim=True)
    v = x.var(dim=axis, keepdim=True, unbiased=False)
    return (x - m) / torch.sqrt(v + eps)
def _scatter_add(tgt, idx, src, axis=0):
    return tgt.clone().index_add_(axis, idx, src)
def _segment_sum(src, seg, n):
    out = torch.zeros((n,) + src.shape[1:], dtype=src.dtype)
    return out.index_add_(0, seg, src)
def _pad(x, pw):
    flat = tuple(v for pair in reversed(pw) for v in pair)
    return torch.nn.functional.pad(x, flat)

kernel_name = 'gated_mix__linear_attn_block__ssm_conv_s4d__prompt'

def setup_inputs():

    _w = (lambda a: (lambda t: t.to(torch.bfloat16) if t.is_floating_point() else t)(torch.as_tensor(a)))
    def _A_setup():
        B, S, D = 1, 2048, 512
        return {
            "x": _w((lambda *s: torch.randn(*s, dtype=torch.bfloat16) * 0.05)(B, S, D)),
            "wqkv": _w((lambda *s: torch.randn(*s, dtype=torch.bfloat16) * 0.8)(D, 3 * D)),
            "wo": _w((lambda *s: torch.randn(*s, dtype=torch.bfloat16) * 0.05)(D, D)),
        }
    _A_in = _A_setup()

    def _B_setup():
        Bsz, L, D, N = 1, 2048, 512, 128
        return {
            "u": _w((lambda *s: torch.randn(*s, dtype=torch.bfloat16) * 0.05)(Bsz, L, D)),
            "log_A_real": _w((lambda *s: torch.randn(*s, dtype=torch.bfloat16) * 6.4)(D, N) * 0.5),
            "A_imag": _w((lambda *s: torch.randn(*s, dtype=torch.bfloat16) * 0.05)(D, N) * 3.14),
            "C_real": _w((lambda *s: torch.randn(*s, dtype=torch.bfloat16) * 0.2)(D, N) / N ** 0.5),
            "C_imag": _w((lambda *s: torch.randn(*s, dtype=torch.bfloat16) * 0.2)(D, N) / N ** 0.5),
            "log_dt": _w((lambda *s: torch.randn(*s, dtype=torch.bfloat16) * 0.05)(D) * 0.5 - 4.0),
            "D_skip": _w((lambda *s: torch.randn(*s, dtype=torch.bfloat16) * 0.05)(D)),
        }
    _B_in = _B_setup()

    return {
        "A_x": _A_in["x"],
        "A_wqkv": _A_in["wqkv"],
        "A_wo": _A_in["wo"],
        "B_u": _B_in["u"],
        "B_log_A_real": _B_in["log_A_real"],
        "B_A_imag": _B_in["A_imag"],
        "B_C_real": _B_in["C_real"],
        "B_C_imag": _B_in["C_imag"],
        "B_log_dt": _B_in["log_dt"],
        "B_D_skip": _B_in["D_skip"],
        "gate_w": _w((lambda *s: torch.randn(*s, dtype=torch.bfloat16) * 0.05)(512) * 16.0),
    }

def reference(A_x, A_wqkv, A_wo, B_u, B_log_A_real, B_A_imag, B_C_real, B_C_imag, B_log_dt, B_D_skip, gate_w):
    def _A_ref(x, wqkv, wo):
        B, S, D = x.shape
        H = 32; Dh = D // H
        qkv = (lambda x, *d: x.permute(*d))((x @ wqkv).reshape(B, S, 3, H, Dh), 2, 0, 3, 1, 4)
        q, k, v = qkv[0], qkv[1], qkv[2]
        phi = lambda t: torch.where(t > 0, t + 1, torch.exp(t)) + 1e-6
        pq, pk = phi(q), phi(k)
        kv = torch.einsum("bhsd,bhse->bhde", pk, v)
        z = torch.einsum("bhsd->bhd", pk)
        num = torch.einsum("bhqd,bhde->bhqe", pq, kv)
        den = torch.einsum("bhqd,bhd->bhq", pq, z)[..., None] + 1e-6
        o = num / den
        return (lambda x, *d: x.permute(*d))(o, 0, 2, 1, 3).reshape(B, S, D) @ wo

    def _B_ref(u, log_A_real, A_imag, C_real, C_imag, log_dt, D_skip):
        L = u.shape[1]
        dt = torch.exp(log_dt)
        A = -torch.exp(log_A_real) + 1j * A_imag
        C = (C_real + 1j * C_imag) * dt[:, None]
        pos = (lambda x, dt: x.to(dt))(torch.arange(L), log_dt.dtype)
        P = torch.exp((A * dt[:, None])[:, :, None] * pos[None, None, :])
        K = 2.0 * torch.einsum("dn,dnl->dl", C, P).real
        L2 = 2 * L
        u_t = (lambda x, *d: x.permute(*d))(u, 0, 2, 1)
        Kf = (lambda x, *a, **k: torch.fft.rfft(x.float(), *a, **k))(K, L2)
        Uf = (lambda x, *a, **k: torch.fft.rfft(x.float(), *a, **k))(u_t, L2)
        y = (lambda x, *a, **k: torch.fft.irfft(x, *a, **k).to(torch.bfloat16))(Uf * Kf[None, :, :], L2)[:, :, :L]
        y = (lambda x, *d: x.permute(*d))(y, 0, 2, 1)
        return y + u * D_skip[None, None, :]

    x = A_x
    g = _sigmoid((x * gate_w).sum(-1, keepdims=True))
    a = _A_ref(x, A_wqkv, A_wo)
    b = _B_ref(x, B_log_A_real, B_A_imag, B_C_real, B_C_imag, B_log_dt, B_D_skip)
    return g * a + (1 - g) * b
```

```asm
; @launch grid=(256,1,1) block=(512,1,1) lds=163840
.amdgcn_target "amdgcn-amd-amdhsa--gfx950"
.text
.globl gated_mix__linear_attn_block__ssm_conv_s4d__prompt_kernel
.p2align 8
.type gated_mix__linear_attn_block__ssm_conv_s4d__prompt_kernel,@function
gated_mix__linear_attn_block__ssm_conv_s4d__prompt_kernel:
    s_cmp_ge_u32 s2, 256
    s_cbranch_scc1 L_end
    s_load_dwordx4 s[4:7], s[0:1], 0
    s_load_dwordx16 s[16:31], s[0:1], 32
    s_load_dwordx4 s[32:35], s[0:1], 96
    s_load_dwordx2 s[12:13], s[0:1], 16
    v_lshrrev_b32 v2, 6, v0
    v_and_b32 v1, 63, v0
    v_readfirstlane_b32 s44, v2
    s_and_b32 s45, s2, 7
    s_bfe_u32 s46, s2, 0x40003
    s_getpc_b64 s[100:101]
    s_and_b32 s100, s100, 0xffffff00
    v_lshlrev_b32 v3, 4, v0
    s_and_b32 s9, s46, 3
    s_lshl_b32 s9, s9, 13
    v_add_u32 v3, s9, v3
    v_min_u32 v3, CODE_END - gated_mix__linear_attn_block__ssm_conv_s4d__prompt_kernel - 16, v3
    v_mov_b32 v5, s101
    v_add_co_u32 v4, vcc, s100, v3
    s_nop 1
    v_addc_co_u32 v5, vcc, 0, v5, vcc
    global_load_dwordx4 v[228:231], v[4:5], off
    v_lshrrev_b32 v254, 3, v1
    v_and_b32 v11, 7, v1
    s_and_b32 s11, s44, 3
    s_lshl_b32 s97, s11, 11
    s_bitcmp1_b32 s2, 7
    s_cbranch_scc0 L_gemm
    s_lshl_b32 s47, s45, 4
    s_add_u32 s47, s47, s46
    s_lshr_b32 s49, s44, 2
    s_lshl_b32 s9, s47, 2
    s_add_u32 s9, s9, s11
    s_lshl_b32 s9, s9, 8
    s_lshl_b32 s10, s49, 7
    s_add_u32 s9, s9, s10
    v_lshlrev_b32 v2, 1, v1
    v_add_u32 v2, s9, v2
    s_lshl_b32 s8, s47, 3
    s_lshr_b32 s9, s46, 1
    s_add_u32 s9, s9, s44
    s_and_b32 s9, s9, 7
    v_bfe_u32 v10, v1, 1, 3
    s_lshl_b32 s10, s9, 3
    v_add_u32 v250, s10, v10
    v_lshrrev_b32 v251, 4, v1
    v_and_b32 v12, 1, v1
    v_lshlrev_b32 v13, 3, v250
    v_lshl_add_u32 v13, v251, 1, v13
    v_add_u32 v13, v13, v12
    v_lshlrev_b32 v13, 12, v13
    v_add_u32 v249, s8, v13
    s_xor_b32 s15, s49, 1
    s_lshl_b32 s15, s15, 7
    s_add_u32 s15, s15, s47
    s_waitcnt lgkmcnt(0)
    global_load_ushort v4, v2, s[16:17]
    global_load_ushort v5, v2, s[18:19]
    global_load_ushort v6, v2, s[20:21]
    global_load_ushort v7, v2, s[22:23]
    s_load_dwordx2 s[52:53], s[24:25], s8
    s_load_dwordx2 s[54:55], s[26:27], s8
    s_cmp_lt_u32 s15, 8
    s_cbranch_scc1 L_zero
L_zero_back:
    s_barrier
    global_load_dwordx2 v[240:241], v249, s[4:5]
    global_load_dwordx2 v[242:243], v249, s[4:5] offset:1024
    s_branch L_ssm
L_gemm:
    s_lshr_b32 s47, s45, 1
    s_lshl_b32 s47, s47, 2
    s_lshr_b32 s3, s46, 2
    s_add_u32 s47, s47, s3
    s_and_b32 s48, s45, 1
    s_lshl_b32 s48, s48, 2
    s_and_b32 s8, s46, 3
    s_add_u32 s48, s48, s8
    s_add_u32 s49, s3, s8
    s_lshl_b32 s49, s49, 1
    s_lshr_b32 s9, s45, 1
    s_xor_b32 s9, s9, s45
    s_and_b32 s9, s9, 1
    s_add_u32 s49, s49, s9
    s_and_b32 s49, s49, 7
    v_lshrrev_b32 v10, 2, v1
    v_and_b32 v10, 4, v10
    v_xor_b32 v10, v10, v11
    v_lshlrev_b32 v10, 4, v10
    v_mul_u32_u24 v252, 3072, v254
    v_add_u32 v252, v252, v10
    s_lshl_b32 s9, s48, 7
    s_mul_i32 s52, s11, 49152
    s_add_u32 s52, s52, s9
    s_cmp_lt_u32 s44, 4
    s_cbranch_scc1 L_gA
    v_lshrrev_b32 v10, 4, v1
    v_xor_b32 v10, v10, v11
    v_lshlrev_b32 v10, 4, v10
    v_lshl_add_u32 v2, v254, 10, v10
    v_xor_b32 v3, 64, v2
    s_lshl_b32 s50, s47, 17
    s_lshl_b32 s10, s11, 14
    s_add_u32 s50, s50, s10
    s_lshr_b32 s10, s11, 1
    s_add_u32 s10, s10, 1
    s_lshl_b32 s51, s10, 10
    s_add_u32 s51, s51, s9
    s_and_b32 s10, s11, 1
    s_mul_i32 s10, s10, 49152
    s_add_u32 s51, s51, s10
    s_mov_b32 s38, 2097152
    s_mov_b32 s39, 0x00020000
    s_mov_b32 s42, 1572864
    s_mov_b32 s43, 0x00020000
    s_waitcnt lgkmcnt(0)
    s_mov_b32 s36, s4
    s_and_b32 s37, s5, 0xffff
    s_mov_b32 s40, s6
    s_and_b32 s41, s7, 0xffff
    s_add_u32 s53, s49, 0
    s_and_b32 s53, s53, 7
    s_lshl_b32 s54, s53, 7
    s_add_u32 s54, s54, s50
    s_add_u32 m0, s97, 0
    s_add_u32 s54, s54, 0
    buffer_load_dwordx4 v2, s[36:39], s54 offen lds
    s_add_u32 m0, s97, 1024
    s_add_u32 s54, s54, 8192
    buffer_load_dwordx4 v3, s[36:39], s54 offen lds
    s_add_u32 s53, s49, 0
    s_and_b32 s53, s53, 7
    s_lshl_b32 s54, s53, 7
    s_add_u32 s54, s54, s50
    s_add_u32 m0, s97, 8192
    s_add_u32 s54, s54, 65536
    buffer_load_dwordx4 v2, s[36:39], s54 offen lds
    s_add_u32 m0, s97, 9216
    s_add_u32 s54, s54, 8192
    buffer_load_dwordx4 v3, s[36:39], s54 offen lds
    s_add_u32 s53, s49, 0
    s_and_b32 s53, s53, 7
    s_mul_i32 s55, s53, 196608
    s_add_u32 s55, s55, s51
    s_add_u32 m0, s97, 131072
    s_add_u32 s55, s55, 0
    buffer_load_dwordx4 v252, s[40:43], s55 offen lds
    s_add_u32 m0, s97, 132096
    s_add_u32 s55, s55, 24576
    buffer_load_dwordx4 v252, s[40:43], s55 offen lds
    s_add_u32 s53, s49, 0
    s_and_b32 s53, s53, 7
    s_mul_i32 s55, s53, 196608
    s_add_u32 s55, s55, s51
    s_add_u32 m0, s97, 139264
    s_add_u32 s55, s55, 98304
    buffer_load_dwordx4 v252, s[40:43], s55 offen lds
    s_add_u32 m0, s97, 140288
    s_add_u32 s55, s55, 24576
    buffer_load_dwordx4 v252, s[40:43], s55 offen lds
    s_add_u32 s53, s49, 0
    s_and_b32 s53, s53, 7
    s_mul_i32 s55, s53, 196608
    s_add_u32 s55, s55, s52
    s_add_u32 m0, s97, 98304
    s_add_u32 s55, s55, 0
    buffer_load_dwordx4 v252, s[40:43], s55 offen lds
    s_add_u32 m0, s97, 99328
    s_add_u32 s55, s55, 24576
    buffer_load_dwordx4 v252, s[40:43], s55 offen lds
    v_and_b32 v20, 31, v1
    v_lshrrev_b32 v21, 5, v1
    v_bfe_u32 v22, v1, 1, 3
    v_xor_b32 v22, v22, v21
    s_and_b32 s9, s44, 1
    s_lshl_b32 s9, s9, 13
    v_lshlrev_b32 v20, 7, v20
    v_add_u32 v20, s9, v20
    v_xor_b32 v23, 0, v22
    v_lshl_add_u32 v4, v23, 4, v20
    v_add_u32 v8, 0x10000, v4
    v_xor_b32 v23, 2, v22
    v_lshl_add_u32 v5, v23, 4, v20
    v_add_u32 v9, 0x10000, v5
    v_xor_b32 v23, 4, v22
    v_lshl_add_u32 v6, v23, 4, v20
    v_add_u32 v10, 0x10000, v6
    v_xor_b32 v23, 6, v22
    v_lshl_add_u32 v7, v23, 4, v20
    v_add_u32 v11, 0x10000, v7
    s_lshr_b32 s9, s11, 1
    v_bfe_u32 v20, v1, 2, 2
    v_lshl_add_u32 v22, v21, 3, v20
    v_lshlrev_b32 v22, 7, v22
    v_lshrrev_b32 v20, 1, v20
    v_xor_b32 v20, s9, v20
    v_lshl_add_u32 v22, v20, 6, v22
    v_bfe_u32 v20, v1, 4, 1
    v_lshl_add_u32 v22, v20, 5, v22
    v_and_b32 v20, 3, v1
    v_lshl_add_u32 v22, v20, 3, v22
    v_add_u32 v12, 131072, v22
    v_mov_b32 v201, v22
    v_add_u32 v200, 0x10000, v22
    s_lshl_b32 s9, s47, 2
    s_and_b32 s10, s44, 1
    s_lshl_b32 s10, s10, 1
    s_add_u32 s9, s9, s10
    s_lshl_b32 s9, s9, 5
    s_lshl_b32 s10, s48, 2
    s_add_u32 s9, s9, s10
    s_and_b32 s10, s44, 2
    s_add_u32 s9, s9, s10
    s_lshl_b32 s9, s9, 10
    s_add_u32 s9, s9, 4096
    v_lshlrev_b32 v17, 4, v1
    v_add_u32 v15, s9, v17
    v_add_u32 v16, 0x8000, v15
    s_add_u32 s53, s49, 1
    s_and_b32 s53, s53, 7
    s_lshl_b32 s54, s53, 7
    s_add_u32 s54, s54, s50
    s_add_u32 m0, s97, 16384
    s_add_u32 s54, s54, 0
    buffer_load_dwordx4 v2, s[36:39], s54 offen lds
    s_add_u32 m0, s97, 17408
    s_add_u32 s54, s54, 8192
    buffer_load_dwordx4 v3, s[36:39], s54 offen lds
    s_add_u32 s53, s49, 1
    s_and_b32 s53, s53, 7
    s_lshl_b32 s54, s53, 7
    s_add_u32 s54, s54, s50
    s_add_u32 m0, s97, 24576
    s_add_u32 s54, s54, 65536
    buffer_load_dwordx4 v2, s[36:39], s54 offen lds
    s_add_u32 m0, s97, 25600
    s_add_u32 s54, s54, 8192
    buffer_load_dwordx4 v3, s[36:39], s54 offen lds
    s_add_u32 s53, s49, 1
    s_and_b32 s53, s53, 7
    s_mul_i32 s55, s53, 196608
    s_add_u32 s55, s55, s51
    s_add_u32 m0, s97, 147456
    s_add_u32 s55, s55, 0
    buffer_load_dwordx4 v252, s[40:43], s55 offen lds
    s_add_u32 m0, s97, 148480
    s_add_u32 s55, s55, 24576
    buffer_load_dwordx4 v252, s[40:43], s55 offen lds
    s_setprio 1
    s_waitcnt vmcnt(10) lgkmcnt(0)
    s_barrier
    s_add_u32 s53, s49, 1
    s_and_b32 s53, s53, 7
    s_mul_i32 s55, s53, 196608
    s_add_u32 s55, s55, s51
    s_add_u32 m0, s97, 155648
    s_add_u32 s55, s55, 98304
    buffer_load_dwordx4 v252, s[40:43], s55 offen lds
    s_add_u32 m0, s97, 156672
    s_add_u32 s55, s55, 24576
    buffer_load_dwordx4 v252, s[40:43], s55 offen lds
    s_add_u32 s53, s49, 2
    s_and_b32 s53, s53, 7
    s_lshl_b32 s54, s53, 7
    s_add_u32 s54, s54, s50
    s_add_u32 m0, s97, 32768
    s_add_u32 s54, s54, 0
    buffer_load_dwordx4 v2, s[36:39], s54 offen lds
    s_add_u32 m0, s97, 33792
    s_add_u32 s54, s54, 8192
    buffer_load_dwordx4 v3, s[36:39], s54 offen lds
    s_add_u32 s53, s49, 1
    s_and_b32 s53, s53, 7
    s_mul_i32 s55, s53, 196608
    s_add_u32 s55, s55, s52
    s_add_u32 m0, s97, 106496
    s_add_u32 s55, s55, 0
    buffer_load_dwordx4 v252, s[40:43], s55 offen lds
    s_add_u32 m0, s97, 107520
    s_add_u32 s55, s55, 24576
    buffer_load_dwordx4 v252, s[40:43], s55 offen lds
    s_waitcnt vmcnt(12) lgkmcnt(0)
    s_barrier
    ds_read_b64_tr_b16 v[64:65], v200 offset:32768
    ds_read_b64_tr_b16 v[66:67], v200 offset:33280
    ds_read_b64_tr_b16 v[68:69], v200 offset:34816
    ds_read_b64_tr_b16 v[70:71], v200 offset:35328
    ds_read_b64_tr_b16 v[72:73], v200 offset:36864
    ds_read_b64_tr_b16 v[74:75], v200 offset:37376
    ds_read_b64_tr_b16 v[76:77], v200 offset:38912
    ds_read_b64_tr_b16 v[78:79], v200 offset:39424
    ds_read_b128 v[40:43], v4 offset:0
    ds_read_b128 v[44:47], v4 offset:4096
    s_add_u32 s53, s49, 2
    s_and_b32 s53, s53, 7
    s_mul_i32 s55, s53, 196608
    s_add_u32 s55, s55, s51
    s_add_u32 m0, s97, 131072
    s_add_u32 s55, s55, 0
    buffer_load_dwordx4 v252, s[40:43], s55 offen lds
    s_add_u32 m0, s97, 132096
    s_add_u32 s55, s55, 24576
    buffer_load_dwordx4 v252, s[40:43], s55 offen lds
    s_add_u32 s53, s49, 2
    s_and_b32 s53, s53, 7
    s_lshl_b32 s54, s53, 7
    s_add_u32 s54, s54, s50
    s_add_u32 m0, s97, 40960
    s_add_u32 s54, s54, 65536
    buffer_load_dwordx4 v2, s[36:39], s54 offen lds
    s_add_u32 m0, s97, 41984
    s_add_u32 s54, s54, 8192
    buffer_load_dwordx4 v3, s[36:39], s54 offen lds
    s_waitcnt vmcnt(10) lgkmcnt(0)
    s_barrier
    ds_read_b128 v[24:27], v5 offset:0
    ds_read_b128 v[28:31], v5 offset:4096
    s_add_u32 s53, s49, 2
    s_and_b32 s53, s53, 7
    s_mul_i32 s55, s53, 196608
    s_add_u32 s55, s55, s51
    s_add_u32 m0, s97, 139264
    s_add_u32 s55, s55, 98304
    buffer_load_dwordx4 v252, s[40:43], s55 offen lds
    s_add_u32 m0, s97, 140288
    s_add_u32 s55, s55, 24576
    buffer_load_dwordx4 v252, s[40:43], s55 offen lds
    s_add_u32 s53, s49, 3
    s_and_b32 s53, s53, 7
    s_lshl_b32 s54, s53, 7
    s_add_u32 s54, s54, s50
    s_add_u32 m0, s97, 49152
    s_add_u32 s54, s54, 0
    buffer_load_dwordx4 v2, s[36:39], s54 offen lds
    s_add_u32 m0, s97, 50176
    s_add_u32 s54, s54, 8192
    buffer_load_dwordx4 v3, s[36:39], s54 offen lds
    s_add_u32 s53, s49, 2
    s_and_b32 s53, s53, 7
    s_mul_i32 s55, s53, 196608
    s_add_u32 s55, s55, s52
    s_add_u32 m0, s97, 114688
    s_add_u32 s55, s55, 0
    buffer_load_dwordx4 v252, s[40:43], s55 offen lds
    s_add_u32 m0, s97, 115712
    s_add_u32 s55, s55, 24576
    buffer_load_dwordx4 v252, s[40:43], s55 offen lds
    v_mfma_f32_32x32x16_bf16 v[128:143], v[64:67], v[40:43], 1.0
    v_mfma_f32_32x32x16_bf16 v[144:159], v[64:67], v[44:47], 1.0
    s_waitcnt vmcnt(10) lgkmcnt(0)
    s_barrier
    ds_read_b64_tr_b16 v[80:81], v200 offset:40960
    ds_read_b64_tr_b16 v[82:83], v200 offset:41472
    ds_read_b64_tr_b16 v[84:85], v200 offset:43008
    ds_read_b64_tr_b16 v[86:87], v200 offset:43520
    ds_read_b64_tr_b16 v[88:89], v200 offset:45056
    ds_read_b64_tr_b16 v[90:91], v200 offset:45568
    ds_read_b64_tr_b16 v[92:93], v200 offset:47104
    ds_read_b64_tr_b16 v[94:95], v200 offset:47616
    ds_read_b128 v[40:43], v6 offset:0
    ds_read_b128 v[44:47], v6 offset:4096
    s_add_u32 s53, s49, 3
    s_and_b32 s53, s53, 7
    s_mul_i32 s55, s53, 196608
    s_add_u32 s55, s55, s51
    s_add_u32 m0, s97, 147456
    s_add_u32 s55, s55, 0
    buffer_load_dwordx4 v252, s[40:43], s55 offen lds
    s_add_u32 m0, s97, 148480
    s_add_u32 s55, s55, 24576
    buffer_load_dwordx4 v252, s[40:43], s55 offen lds
    s_add_u32 s53, s49, 3
    s_and_b32 s53, s53, 7
    s_lshl_b32 s54, s53, 7
    s_add_u32 s54, s54, s50
    s_add_u32 m0, s97, 57344
    s_add_u32 s54, s54, 65536
    buffer_load_dwordx4 v2, s[36:39], s54 offen lds
    s_add_u32 m0, s97, 58368
    s_add_u32 s54, s54, 8192
    buffer_load_dwordx4 v3, s[36:39], s54 offen lds
    v_mfma_f32_32x32x16_bf16 v[128:143], v[68:71], v[24:27], v[128:143]
    v_mfma_f32_32x32x16_bf16 v[144:159], v[68:71], v[28:31], v[144:159]
    s_waitcnt vmcnt(10) lgkmcnt(0)
    s_barrier
    ds_read_b128 v[24:27], v7 offset:0
    ds_read_b128 v[28:31], v7 offset:4096
    s_add_u32 s53, s49, 3
    s_and_b32 s53, s53, 7
    s_mul_i32 s55, s53, 196608
    s_add_u32 s55, s55, s51
    s_add_u32 m0, s97, 155648
    s_add_u32 s55, s55, 98304
    buffer_load_dwordx4 v252, s[40:43], s55 offen lds
    s_add_u32 m0, s97, 156672
    s_add_u32 s55, s55, 24576
    buffer_load_dwordx4 v252, s[40:43], s55 offen lds
    s_add_u32 s53, s49, 4
    s_and_b32 s53, s53, 7
    s_lshl_b32 s54, s53, 7
    s_add_u32 s54, s54, s50
    s_add_u32 m0, s97, 65536
    s_add_u32 s54, s54, 0
    buffer_load_dwordx4 v2, s[36:39], s54 offen lds
    s_add_u32 m0, s97, 66560
    s_add_u32 s54, s54, 8192
    buffer_load_dwordx4 v3, s[36:39], s54 offen lds
    s_add_u32 s53, s49, 3
    s_and_b32 s53, s53, 7
    s_mul_i32 s55, s53, 196608
    s_add_u32 s55, s55, s52
    s_add_u32 m0, s97, 122880
    s_add_u32 s55, s55, 0
    buffer_load_dwordx4 v252, s[40:43], s55 offen lds
    s_add_u32 m0, s97, 123904
    s_add_u32 s55, s55, 24576
    buffer_load_dwordx4 v252, s[40:43], s55 offen lds
    v_mfma_f32_32x32x16_bf16 v[128:143], v[72:75], v[40:43], v[128:143]
    v_mfma_f32_32x32x16_bf16 v[144:159], v[72:75], v[44:47], v[144:159]
    s_waitcnt vmcnt(10) lgkmcnt(0)
    s_barrier
    ds_read_b64_tr_b16 v[96:97], v200 offset:49152
    ds_read_b64_tr_b16 v[98:99], v200 offset:49664
    ds_read_b64_tr_b16 v[100:101], v200 offset:51200
    ds_read_b64_tr_b16 v[102:103], v200 offset:51712
    ds_read_b64_tr_b16 v[104:105], v200 offset:53248
    ds_read_b64_tr_b16 v[106:107], v200 offset:53760
    ds_read_b64_tr_b16 v[108:109], v200 offset:55296
    ds_read_b64_tr_b16 v[110:111], v200 offset:55808
    ds_read_b128 v[40:43], v4 offset:16384
    ds_read_b128 v[44:47], v4 offset:20480
    s_add_u32 s53, s49, 4
    s_and_b32 s53, s53, 7
    s_mul_i32 s55, s53, 196608
    s_add_u32 s55, s55, s51
    s_add_u32 m0, s97, 131072
    s_add_u32 s55, s55, 0
    buffer_load_dwordx4 v252, s[40:43], s55 offen lds
    s_add_u32 m0, s97, 132096
    s_add_u32 s55, s55, 24576
    buffer_load_dwordx4 v252, s[40:43], s55 offen lds
    s_add_u32 s53, s49, 4
    s_and_b32 s53, s53, 7
    s_lshl_b32 s54, s53, 7
    s_add_u32 s54, s54, s50
    s_add_u32 m0, s97, 73728
    s_add_u32 s54, s54, 65536
    buffer_load_dwordx4 v2, s[36:39], s54 offen lds
    s_add_u32 m0, s97, 74752
    s_add_u32 s54, s54, 8192
    buffer_load_dwordx4 v3, s[36:39], s54 offen lds
    v_mfma_f32_32x32x16_bf16 v[128:143], v[76:79], v[24:27], v[128:143]
    v_mfma_f32_32x32x16_bf16 v[144:159], v[76:79], v[28:31], v[144:159]
    s_waitcnt vmcnt(10) lgkmcnt(0)
    s_barrier
    ds_read_b128 v[24:27], v5 offset:16384
    ds_read_b128 v[28:31], v5 offset:20480
    s_add_u32 s53, s49, 4
    s_and_b32 s53, s53, 7
    s_mul_i32 s55, s53, 196608
    s_add_u32 s55, s55, s51
    s_add_u32 m0, s97, 139264
    s_add_u32 s55, s55, 98304
    buffer_load_dwordx4 v252, s[40:43], s55 offen lds
    s_add_u32 m0, s97, 140288
    s_add_u32 s55, s55, 24576
    buffer_load_dwordx4 v252, s[40:43], s55 offen lds
    s_add_u32 s53, s49, 5
    s_and_b32 s53, s53, 7
    s_lshl_b32 s54, s53, 7
    s_add_u32 s54, s54, s50
    s_add_u32 m0, s97, 81920
    s_add_u32 s54, s54, 0
    buffer_load_dwordx4 v2, s[36:39], s54 offen lds
    s_add_u32 m0, s97, 82944
    s_add_u32 s54, s54, 8192
    buffer_load_dwordx4 v3, s[36:39], s54 offen lds
    v_mfma_f32_32x32x16_bf16 v[128:143], v[80:83], v[40:43], v[128:143]
    v_mfma_f32_32x32x16_bf16 v[144:159], v[80:83], v[44:47], v[144:159]
    s_waitcnt vmcnt(8) lgkmcnt(0)
    s_barrier
    ds_read_b64_tr_b16 v[112:113], v200 offset:57344
    ds_read_b64_tr_b16 v[114:115], v200 offset:57856
    ds_read_b64_tr_b16 v[116:117], v200 offset:59392
    ds_read_b64_tr_b16 v[118:119], v200 offset:59904
    ds_read_b64_tr_b16 v[120:121], v200 offset:61440
    ds_read_b64_tr_b16 v[122:123], v200 offset:61952
    ds_read_b64_tr_b16 v[124:125], v200 offset:63488
    ds_read_b64_tr_b16 v[126:127], v200 offset:64000
    ds_read_b128 v[40:43], v6 offset:16384
    ds_read_b128 v[44:47], v6 offset:20480
    s_add_u32 s53, s49, 5
    s_and_b32 s53, s53, 7
    s_mul_i32 s55, s53, 196608
    s_add_u32 s55, s55, s51
    s_add_u32 m0, s97, 147456
    s_add_u32 s55, s55, 0
    buffer_load_dwordx4 v252, s[40:43], s55 offen lds
    s_add_u32 m0, s97, 148480
    s_add_u32 s55, s55, 24576
    buffer_load_dwordx4 v252, s[40:43], s55 offen lds
    s_add_u32 s53, s49, 5
    s_and_b32 s53, s53, 7
    s_lshl_b32 s54, s53, 7
    s_add_u32 s54, s54, s50
    s_add_u32 m0, s97, 90112
    s_add_u32 s54, s54, 65536
    buffer_load_dwordx4 v2, s[36:39], s54 offen lds
    s_add_u32 m0, s97, 91136
    s_add_u32 s54, s54, 8192
    buffer_load_dwordx4 v3, s[36:39], s54 offen lds
    v_mfma_f32_32x32x16_bf16 v[128:143], v[84:87], v[24:27], v[128:143]
    v_mfma_f32_32x32x16_bf16 v[144:159], v[84:87], v[28:31], v[144:159]
    s_waitcnt vmcnt(8) lgkmcnt(0)
    s_barrier
    ds_read_b128 v[24:27], v7 offset:16384
    ds_read_b128 v[28:31], v7 offset:20480
    s_add_u32 s53, s49, 5
    s_and_b32 s53, s53, 7
    s_mul_i32 s55, s53, 196608
    s_add_u32 s55, s55, s51
    s_add_u32 m0, s97, 155648
    s_add_u32 s55, s55, 98304
    buffer_load_dwordx4 v252, s[40:43], s55 offen lds
    s_add_u32 m0, s97, 156672
    s_add_u32 s55, s55, 24576
    buffer_load_dwordx4 v252, s[40:43], s55 offen lds
    s_add_u32 s53, s49, 6
    s_and_b32 s53, s53, 7
    s_lshl_b32 s54, s53, 7
    s_add_u32 s54, s54, s50
    s_add_u32 m0, s97, 98304
    s_add_u32 s54, s54, 0
    buffer_load_dwordx4 v2, s[36:39], s54 offen lds
    s_add_u32 m0, s97, 99328
    s_add_u32 s54, s54, 8192
    buffer_load_dwordx4 v3, s[36:39], s54 offen lds
    v_mfma_f32_32x32x16_bf16 v[128:143], v[88:91], v[40:43], v[128:143]
    v_mfma_f32_32x32x16_bf16 v[144:159], v[88:91], v[44:47], v[144:159]
    s_waitcnt vmcnt(10) lgkmcnt(0)
    s_barrier
    s_add_u32 s53, s49, 6
    s_and_b32 s53, s53, 7
    s_mul_i32 s55, s53, 196608
    s_add_u32 s55, s55, s51
    s_add_u32 m0, s97, 131072
    s_add_u32 s55, s55, 0
    buffer_load_dwordx4 v252, s[40:43], s55 offen lds
    s_add_u32 m0, s97, 132096
    s_add_u32 s55, s55, 24576
    buffer_load_dwordx4 v252, s[40:43], s55 offen lds
    s_add_u32 s53, s49, 6
    s_and_b32 s53, s53, 7
    s_lshl_b32 s54, s53, 7
    s_add_u32 s54, s54, s50
    s_add_u32 m0, s97, 106496
    s_add_u32 s54, s54, 65536
    buffer_load_dwordx4 v2, s[36:39], s54 offen lds
    s_add_u32 m0, s97, 107520
    s_add_u32 s54, s54, 8192
    buffer_load_dwordx4 v3, s[36:39], s54 offen lds
    s_and_b32 s63, s46, 3
    s_lshr_b32 s62, s46, 2
    s_lshl_b32 s62, s62, 1
    s_bfe_u32 s9, s2, 65543
    s_add_u32 s62, s62, s9
    s_lshl_b32 s9, s45, 3
    s_add_u32 s62, s62, s9
    v_lshrrev_b32 v255, 2, v1
    v_and_b32 v255, 4, v255
    v_and_b32 v253, 7, v1
    v_xor_b32 v255, v255, v253
    v_lshlrev_b32 v255, 4, v255
    v_lshl_add_u32 v253, v254, 10, v255
    v_lshrrev_b32 v255, 5, v1
    v_bfe_u32 v237, v1, 2, 2
    v_lshl_add_u32 v238, v255, 2, v237
    v_lshlrev_b32 v238, 7, v238
    v_lshrrev_b32 v237, 1, v237
    s_and_b32 s9, s11, 1
    v_xor_b32 v237, s9, v237
    v_lshl_add_u32 v238, v237, 6, v238
    v_bfe_u32 v237, v1, 4, 1
    v_lshl_add_u32 v238, v237, 5, v238
    v_and_b32 v237, 3, v1
    v_lshl_add_u32 v238, v237, 3, v238
    s_lshr_b32 s9, s11, 1
    s_lshl_b32 s9, s9, 15
    v_add_u32 v238, s9, v238
    s_mov_b32 s14, 0
    s_lshl_b32 s96, s11, 14
    s_lshl_b32 s9, s63, 8
    s_add_u32 s96, s96, s9
    s_mov_b32 s92, s12
    s_and_b32 s93, s13, 0xffff
    s_mov_b32 s94, 524288
    s_mov_b32 s95, 0x00020000
    s_mov_b32 s56, 0x3fb8aa3b
    s_mov_b32 s57, 0x3fb8aa3b
    s_mov_b32 s58, 0x358637bd
    s_mov_b32 s59, 0x358637bd
    v_mov_b32 v18, 0xbfb8aa3b
    v_mov_b32 v19, 0xbfb8aa3b
    v_mfma_f32_32x32x16_bf16 v[128:143], v[92:95], v[24:27], v[128:143]
    v_mfma_f32_32x32x16_bf16 v[144:159], v[92:95], v[28:31], v[144:159]
    s_waitcnt vmcnt(8) lgkmcnt(0)
    s_barrier
    s_add_u32 s53, s49, 6
    s_and_b32 s53, s53, 7
    s_mul_i32 s55, s53, 196608
    s_add_u32 s55, s55, s51
    s_add_u32 m0, s97, 139264
    s_add_u32 s55, s55, 98304
    buffer_load_dwordx4 v252, s[40:43], s55 offen lds
    s_add_u32 m0, s97, 140288
    s_add_u32 s55, s55, 24576
    buffer_load_dwordx4 v252, s[40:43], s55 offen lds
    s_add_u32 s53, s49, 7
    s_and_b32 s53, s53, 7
    s_lshl_b32 s54, s53, 7
    s_add_u32 s54, s54, s50
    s_add_u32 m0, s97, 114688
    s_add_u32 s54, s54, 0
    buffer_load_dwordx4 v2, s[36:39], s54 offen lds
    s_add_u32 m0, s97, 115712
    s_add_u32 s54, s54, 8192
    buffer_load_dwordx4 v3, s[36:39], s54 offen lds
    s_waitcnt vmcnt(10) lgkmcnt(0)
    s_barrier
    s_add_u32 s53, s49, 7
    s_and_b32 s53, s53, 7
    s_mul_i32 s55, s53, 196608
    s_add_u32 s55, s55, s51
    s_add_u32 m0, s97, 147456
    s_add_u32 s55, s55, 0
    buffer_load_dwordx4 v252, s[40:43], s55 offen lds
    s_add_u32 m0, s97, 148480
    s_add_u32 s55, s55, 24576
    buffer_load_dwordx4 v252, s[40:43], s55 offen lds
    s_add_u32 s53, s49, 7
    s_and_b32 s53, s53, 7
    s_lshl_b32 s54, s53, 7
    s_add_u32 s54, s54, s50
    s_add_u32 m0, s97, 122880
    s_add_u32 s54, s54, 65536
    buffer_load_dwordx4 v2, s[36:39], s54 offen lds
    s_add_u32 m0, s97, 123904
    s_add_u32 s54, s54, 8192
    buffer_load_dwordx4 v3, s[36:39], s54 offen lds
    s_waitcnt vmcnt(8) lgkmcnt(0)
    s_barrier
    s_add_u32 s53, s49, 7
    s_and_b32 s53, s53, 7
    s_mul_i32 s55, s53, 196608
    s_add_u32 s55, s55, s51
    s_add_u32 m0, s97, 155648
    s_add_u32 s55, s55, 98304
    buffer_load_dwordx4 v252, s[40:43], s55 offen lds
    s_add_u32 m0, s97, 156672
    s_add_u32 s55, s55, 24576
    buffer_load_dwordx4 v252, s[40:43], s55 offen lds
    s_add_u32 s53, s49, 7
    s_and_b32 s53, s53, 7
    s_mul_i32 s55, s53, 196608
    s_add_u32 s55, s55, s52
    s_add_u32 m0, s97, 8192
    s_add_u32 s55, s55, 0
    buffer_load_dwordx4 v252, s[40:43], s55 offen lds
    s_add_u32 m0, s97, 9216
    s_add_u32 s55, s55, 24576
    buffer_load_dwordx4 v252, s[40:43], s55 offen lds
    v_and_b32 v202, 7, v1
    v_lshlrev_b32 v202, 2, v202
    global_load_dword v203, v202, s[32:33] sc1
    s_waitcnt vmcnt(11) lgkmcnt(0)
    s_barrier
    s_add_u32 s53, s49, 4
    s_and_b32 s53, s53, 7
    s_mul_i32 s55, s53, 196608
    s_add_u32 s55, s55, s52
    s_add_u32 m0, s97, 131072
    s_add_u32 s55, s55, 0
    buffer_load_dwordx4 v252, s[40:43], s55 offen lds
    s_add_u32 m0, s97, 132096
    s_add_u32 s55, s55, 24576
    buffer_load_dwordx4 v252, s[40:43], s55 offen lds
    s_waitcnt vmcnt(7) lgkmcnt(0)
    s_barrier
    s_add_u32 s53, s49, 5
    s_and_b32 s53, s53, 7
    s_mul_i32 s55, s53, 196608
    s_add_u32 s55, s55, s52
    s_add_u32 m0, s97, 139264
    s_add_u32 s55, s55, 0
    buffer_load_dwordx4 v252, s[40:43], s55 offen lds
    s_add_u32 m0, s97, 140288
    s_add_u32 s55, s55, 24576
    buffer_load_dwordx4 v252, s[40:43], s55 offen lds
    s_waitcnt vmcnt(7) lgkmcnt(0)
    s_barrier
    s_add_u32 s53, s49, 6
    s_and_b32 s53, s53, 7
    s_mul_i32 s55, s53, 196608
    s_add_u32 s55, s55, s52
    s_add_u32 m0, s97, 147456
    s_add_u32 s55, s55, 0
    buffer_load_dwordx4 v252, s[40:43], s55 offen lds
    s_add_u32 m0, s97, 148480
    s_add_u32 s55, s55, 24576
    buffer_load_dwordx4 v252, s[40:43], s55 offen lds
    s_add_u32 m0, s97, 0
    s_add_u32 s9, s96, 0
    buffer_load_dwordx4 v253, s[92:95], s9 offen lds
    s_add_u32 m0, s97, 1024
    s_add_u32 s9, s9, 8192
    buffer_load_dwordx4 v253, s[92:95], s9 offen lds
    s_setprio 1
    s_waitcnt vmcnt(2) lgkmcnt(0)
    s_barrier
    ds_read_b128 v[24:27], v4 offset:32768
    ds_read_b128 v[28:31], v4 offset:36864
    ds_read_b128 v[36:39], v5 offset:32768
    ds_read_b128 v[40:43], v5 offset:36864
    ds_read_b128 v[64:67], v6 offset:32768
    ds_read_b128 v[68:71], v6 offset:36864
    s_waitcnt lgkmcnt(5)
    v_mfma_f32_32x32x16_bf16 v[128:143], v[96:99], v[24:27], v[128:143]
    s_waitcnt lgkmcnt(4)
    v_mfma_f32_32x32x16_bf16 v[144:159], v[96:99], v[28:31], v[144:159]
    ds_read_b128 v[76:79], v7 offset:32768
    ds_read_b128 v[80:83], v7 offset:36864
    s_waitcnt lgkmcnt(5)
    v_mfma_f32_32x32x16_bf16 v[128:143], v[100:103], v[36:39], v[128:143]
    s_waitcnt lgkmcnt(4)
    v_mfma_f32_32x32x16_bf16 v[144:159], v[100:103], v[40:43], v[144:159]
    ds_read_b128 v[24:27], v4 offset:49152
    ds_read_b128 v[28:31], v4 offset:53248
    s_waitcnt lgkmcnt(5)
    v_mfma_f32_32x32x16_bf16 v[128:143], v[104:107], v[64:67], v[128:143]
    s_waitcnt lgkmcnt(4)
    v_mfma_f32_32x32x16_bf16 v[144:159], v[104:107], v[68:71], v[144:159]
    ds_read_b128 v[36:39], v5 offset:49152
    ds_read_b128 v[40:43], v5 offset:53248
    s_waitcnt lgkmcnt(5)
    v_mfma_f32_32x32x16_bf16 v[128:143], v[108:111], v[76:79], v[128:143]
    s_waitcnt lgkmcnt(4)
    v_mfma_f32_32x32x16_bf16 v[144:159], v[108:111], v[80:83], v[144:159]
    ds_read_b128 v[64:67], v6 offset:49152
    ds_read_b128 v[68:71], v6 offset:53248
    s_waitcnt lgkmcnt(5)
    v_mfma_f32_32x32x16_bf16 v[128:143], v[112:115], v[24:27], v[128:143]
    s_waitcnt lgkmcnt(4)
    v_mfma_f32_32x32x16_bf16 v[144:159], v[112:115], v[28:31], v[144:159]
    ds_read_b128 v[76:79], v7 offset:49152
    ds_read_b128 v[80:83], v7 offset:53248
    s_waitcnt lgkmcnt(5)
    v_mfma_f32_32x32x16_bf16 v[128:143], v[116:119], v[36:39], v[128:143]
    s_waitcnt lgkmcnt(4)
    v_mfma_f32_32x32x16_bf16 v[144:159], v[116:119], v[40:43], v[144:159]
    ds_read_b128 v[24:27], v8 offset:0
    ds_read_b64_tr_b16 v[32:33], v12 offset:0
    ds_read_b64_tr_b16 v[34:35], v12 offset:512
    ds_read_b128 v[28:31], v8 offset:4096
    s_waitcnt lgkmcnt(7)
    v_mfma_f32_32x32x16_bf16 v[128:143], v[120:123], v[64:67], v[128:143]
    s_waitcnt lgkmcnt(6)
    v_mfma_f32_32x32x16_bf16 v[144:159], v[120:123], v[68:71], v[144:159]
    ds_read_b128 v[36:39], v9 offset:0
    ds_read_b64_tr_b16 v[44:45], v12 offset:2048
    ds_read_b64_tr_b16 v[46:47], v12 offset:2560
    ds_read_b128 v[40:43], v9 offset:4096
    s_waitcnt lgkmcnt(9)
    v_mfma_f32_32x32x16_bf16 v[128:143], v[124:127], v[76:79], v[128:143]
    s_waitcnt lgkmcnt(8)
    v_mfma_f32_32x32x16_bf16 v[144:159], v[124:127], v[80:83], v[144:159]
    ds_read_b128 v[64:67], v10 offset:0
    ds_read_b64_tr_b16 v[72:73], v12 offset:4096
    ds_read_b64_tr_b16 v[74:75], v12 offset:4608
    ds_read_b128 v[68:71], v10 offset:4096
    s_waitcnt lgkmcnt(9)
    v_mfma_f32_32x32x16_bf16 v[128:143], v[32:35], v[24:27], v[128:143]
    s_waitcnt lgkmcnt(8)
    v_mfma_f32_32x32x16_bf16 v[144:159], v[32:35], v[28:31], v[144:159]
    ds_read_b128 v[76:79], v11 offset:0
    ds_read_b64_tr_b16 v[84:85], v12 offset:6144
    ds_read_b64_tr_b16 v[86:87], v12 offset:6656
    ds_read_b128 v[80:83], v11 offset:4096
    s_waitcnt lgkmcnt(9)
    v_mfma_f32_32x32x16_bf16 v[128:143], v[44:47], v[36:39], v[128:143]
    s_waitcnt lgkmcnt(8)
    v_mfma_f32_32x32x16_bf16 v[144:159], v[44:47], v[40:43], v[144:159]
    ds_read_b128 v[24:27], v8 offset:16384
    ds_read_b64_tr_b16 v[32:33], v12 offset:8192
    ds_read_b64_tr_b16 v[34:35], v12 offset:8704
    ds_read_b128 v[28:31], v8 offset:20480
    s_waitcnt lgkmcnt(9)
    v_mfma_f32_32x32x16_bf16 v[128:143], v[72:75], v[64:67], v[128:143]
    s_waitcnt lgkmcnt(8)
    v_mfma_f32_32x32x16_bf16 v[144:159], v[72:75], v[68:71], v[144:159]
    ds_read_b128 v[36:39], v9 offset:16384
    ds_read_b64_tr_b16 v[44:45], v12 offset:10240
    ds_read_b64_tr_b16 v[46:47], v12 offset:10752
    ds_read_b128 v[40:43], v9 offset:20480
    s_waitcnt lgkmcnt(9)
    v_mfma_f32_32x32x16_bf16 v[128:143], v[84:87], v[76:79], v[128:143]
    s_waitcnt lgkmcnt(8)
    v_mfma_f32_32x32x16_bf16 v[144:159], v[84:87], v[80:83], v[144:159]
    ds_read_b128 v[64:67], v10 offset:16384
    ds_read_b64_tr_b16 v[72:73], v12 offset:12288
    ds_read_b64_tr_b16 v[74:75], v12 offset:12800
    ds_read_b128 v[68:71], v10 offset:20480
    s_waitcnt lgkmcnt(9)
    v_mfma_f32_32x32x16_bf16 v[128:143], v[32:35], v[24:27], v[128:143]
    s_waitcnt lgkmcnt(8)
    v_mfma_f32_32x32x16_bf16 v[144:159], v[32:35], v[28:31], v[144:159]
    ds_read_b128 v[76:79], v11 offset:16384
    ds_read_b64_tr_b16 v[84:85], v12 offset:14336
    ds_read_b64_tr_b16 v[86:87], v12 offset:14848
    ds_read_b128 v[80:83], v11 offset:20480
    s_waitcnt lgkmcnt(9)
    v_mfma_f32_32x32x16_bf16 v[128:143], v[44:47], v[36:39], v[128:143]
    s_waitcnt lgkmcnt(8)
    v_mfma_f32_32x32x16_bf16 v[144:159], v[44:47], v[40:43], v[144:159]
    ds_read_b128 v[24:27], v8 offset:32768
    ds_read_b64_tr_b16 v[32:33], v12 offset:16384
    ds_read_b64_tr_b16 v[34:35], v12 offset:16896
    ds_read_b128 v[28:31], v8 offset:36864
    s_waitcnt lgkmcnt(9)
    v_mfma_f32_32x32x16_bf16 v[128:143], v[72:75], v[64:67], v[128:143]
    s_waitcnt lgkmcnt(8)
    v_mfma_f32_32x32x16_bf16 v[144:159], v[72:75], v[68:71], v[144:159]
    ds_read_b128 v[36:39], v9 offset:32768
    ds_read_b64_tr_b16 v[44:45], v12 offset:18432
    ds_read_b64_tr_b16 v[46:47], v12 offset:18944
    ds_read_b128 v[40:43], v9 offset:36864
    s_waitcnt lgkmcnt(9)
    v_mfma_f32_32x32x16_bf16 v[128:143], v[84:87], v[76:79], v[128:143]
    s_waitcnt lgkmcnt(8)
    v_mfma_f32_32x32x16_bf16 v[144:159], v[84:87], v[80:83], v[144:159]
    ds_read_b128 v[64:67], v10 offset:32768
    ds_read_b64_tr_b16 v[72:73], v12 offset:20480
    ds_read_b64_tr_b16 v[74:75], v12 offset:20992
    ds_read_b128 v[68:71], v10 offset:36864
    s_waitcnt lgkmcnt(9)
    v_mfma_f32_32x32x16_bf16 v[128:143], v[32:35], v[24:27], v[128:143]
    s_waitcnt lgkmcnt(8)
    v_mfma_f32_32x32x16_bf16 v[144:159], v[32:35], v[28:31], v[144:159]
    ds_read_b128 v[76:79], v11 offset:32768
    ds_read_b64_tr_b16 v[84:85], v12 offset:22528
    ds_read_b64_tr_b16 v[86:87], v12 offset:23040
    ds_read_b128 v[80:83], v11 offset:36864
    s_waitcnt lgkmcnt(9)
    v_mfma_f32_32x32x16_bf16 v[128:143], v[44:47], v[36:39], v[128:143]
    s_waitcnt lgkmcnt(8)
    v_mfma_f32_32x32x16_bf16 v[144:159], v[44:47], v[40:43], v[144:159]
    ds_read_b128 v[24:27], v8 offset:49152
    ds_read_b64_tr_b16 v[32:33], v201 offset:8192
    ds_read_b64_tr_b16 v[34:35], v201 offset:8704
    ds_read_b128 v[28:31], v8 offset:53248
    s_waitcnt lgkmcnt(9)
    v_mfma_f32_32x32x16_bf16 v[128:143], v[72:75], v[64:67], v[128:143]
    s_waitcnt lgkmcnt(8)
    v_mfma_f32_32x32x16_bf16 v[144:159], v[72:75], v[68:71], v[144:159]
    ds_read_b128 v[36:39], v9 offset:49152
    ds_read_b64_tr_b16 v[44:45], v201 offset:10240
    ds_read_b64_tr_b16 v[46:47], v201 offset:10752
    ds_read_b128 v[40:43], v9 offset:53248
    s_waitcnt lgkmcnt(9)
    v_mfma_f32_32x32x16_bf16 v[128:143], v[84:87], v[76:79], v[128:143]
    s_waitcnt lgkmcnt(8)
    v_mfma_f32_32x32x16_bf16 v[144:159], v[84:87], v[80:83], v[144:159]
    ds_read_b128 v[64:67], v10 offset:49152
    ds_read_b64_tr_b16 v[72:73], v201 offset:12288
    ds_read_b64_tr_b16 v[74:75], v201 offset:12800
    ds_read_b128 v[68:71], v10 offset:53248
    s_waitcnt lgkmcnt(9)
    v_mfma_f32_32x32x16_bf16 v[128:143], v[32:35], v[24:27], v[128:143]
    s_waitcnt lgkmcnt(8)
    v_mfma_f32_32x32x16_bf16 v[144:159], v[32:35], v[28:31], v[144:159]
    ds_read_b128 v[76:79], v11 offset:49152
    ds_read_b64_tr_b16 v[84:85], v201 offset:14336
    ds_read_b64_tr_b16 v[86:87], v201 offset:14848
    ds_read_b128 v[80:83], v11 offset:53248
    s_waitcnt lgkmcnt(9)
    v_mfma_f32_32x32x16_bf16 v[128:143], v[44:47], v[36:39], v[128:143]
    s_waitcnt lgkmcnt(8)
    v_mfma_f32_32x32x16_bf16 v[144:159], v[44:47], v[40:43], v[144:159]
    s_waitcnt lgkmcnt(5)
    v_mfma_f32_32x32x16_bf16 v[128:143], v[72:75], v[64:67], v[128:143]
    s_waitcnt lgkmcnt(4)
    v_mfma_f32_32x32x16_bf16 v[144:159], v[72:75], v[68:71], v[144:159]
    s_waitcnt lgkmcnt(1)
    v_mfma_f32_32x32x16_bf16 v[128:143], v[84:87], v[76:79], v[128:143]
    s_waitcnt lgkmcnt(0)
    v_mfma_f32_32x32x16_bf16 v[144:159], v[84:87], v[80:83], v[144:159]
    s_nop 9
    v_pk_fma_f32 v[56:57], v[128:129], s[56:57], v[18:19]
    v_pk_fma_f32 v[58:59], v[130:131], s[56:57], v[18:19]
    v_exp_f32_e64 v56, v56 clamp
    v_exp_f32_e64 v57, v57 clamp
    v_pk_fma_f32 v[60:61], v[132:133], s[56:57], v[18:19]
    v_exp_f32_e64 v58, v58 clamp
    v_exp_f32_e64 v59, v59 clamp
    v_max_f32 v128, v128, v56
    v_max_f32 v129, v129, v57
    v_pk_fma_f32 v[62:63], v[134:135], s[56:57], v[18:19]
    v_exp_f32_e64 v60, v60 clamp
    v_exp_f32_e64 v61, v61 clamp
    v_max_f32 v130, v130, v58
    v_max_f32 v131, v131, v59
    v_pk_add_f32 v[128:129], v[128:129], s[58:59]
    v_pk_fma_f32 v[56:57], v[136:137], s[56:57], v[18:19]
    v_exp_f32_e64 v62, v62 clamp
    v_exp_f32_e64 v63, v63 clamp
    v_max_f32 v132, v132, v60
    v_max_f32 v133, v133, v61
    v_pk_add_f32 v[130:131], v[130:131], s[58:59]
    v_cvt_pk_bf16_f32 v160, v128, v129
    v_pk_fma_f32 v[58:59], v[138:139], s[56:57], v[18:19]
    v_exp_f32_e64 v56, v56 clamp
    v_exp_f32_e64 v57, v57 clamp
    v_max_f32 v134, v134, v62
    v_max_f32 v135, v135, v63
    v_pk_add_f32 v[132:133], v[132:133], s[58:59]
    v_cvt_pk_bf16_f32 v161, v130, v131
    v_pk_fma_f32 v[60:61], v[140:141], s[56:57], v[18:19]
    v_exp_f32_e64 v58, v58 clamp
    v_exp_f32_e64 v59, v59 clamp
    v_max_f32 v136, v136, v56
    v_max_f32 v137, v137, v57
    v_pk_add_f32 v[134:135], v[134:135], s[58:59]
    v_cvt_pk_bf16_f32 v162, v132, v133
    v_pk_fma_f32 v[62:63], v[142:143], s[56:57], v[18:19]
    v_exp_f32_e64 v60, v60 clamp
    v_exp_f32_e64 v61, v61 clamp
    v_max_f32 v138, v138, v58
    v_max_f32 v139, v139, v59
    v_pk_add_f32 v[136:137], v[136:137], s[58:59]
    v_cvt_pk_bf16_f32 v163, v134, v135
    v_exp_f32_e64 v62, v62 clamp
    v_exp_f32_e64 v63, v63 clamp
    v_max_f32 v140, v140, v60
    v_max_f32 v141, v141, v61
    v_pk_add_f32 v[138:139], v[138:139], s[58:59]
    v_cvt_pk_bf16_f32 v164, v136, v137
    v_max_f32 v142, v142, v62
    v_max_f32 v143, v143, v63
    v_pk_add_f32 v[140:141], v[140:141], s[58:59]
    v_cvt_pk_bf16_f32 v165, v138, v139
    v_pk_add_f32 v[142:143], v[142:143], s[58:59]
    v_cvt_pk_bf16_f32 v166, v140, v141
    v_cvt_pk_bf16_f32 v167, v142, v143
    global_store_dwordx4 v15, v[160:163], s[34:35] sc1
    global_store_dwordx4 v15, v[164:167], s[34:35] offset:1024 sc1
    v_pk_fma_f32 v[56:57], v[144:145], s[56:57], v[18:19]
    v_pk_fma_f32 v[58:59], v[146:147], s[56:57], v[18:19]
    v_exp_f32_e64 v56, v56 clamp
    v_exp_f32_e64 v57, v57 clamp
    v_pk_fma_f32 v[60:61], v[148:149], s[56:57], v[18:19]
    v_exp_f32_e64 v58, v58 clamp
    v_exp_f32_e64 v59, v59 clamp
    v_max_f32 v144, v144, v56
    v_max_f32 v145, v145, v57
    v_pk_fma_f32 v[62:63], v[150:151], s[56:57], v[18:19]
    v_exp_f32_e64 v60, v60 clamp
    v_exp_f32_e64 v61, v61 clamp
    v_max_f32 v146, v146, v58
    v_max_f32 v147, v147, v59
    v_pk_add_f32 v[144:145], v[144:145], s[58:59]
    v_pk_fma_f32 v[56:57], v[152:153], s[56:57], v[18:19]
    v_exp_f32_e64 v62, v62 clamp
    v_exp_f32_e64 v63, v63 clamp
    v_max_f32 v148, v148, v60
    v_max_f32 v149, v149, v61
    v_pk_add_f32 v[146:147], v[146:147], s[58:59]
    v_cvt_pk_bf16_f32 v168, v144, v145
    v_pk_fma_f32 v[58:59], v[154:155], s[56:57], v[18:19]
    v_exp_f32_e64 v56, v56 clamp
    v_exp_f32_e64 v57, v57 clamp
    v_max_f32 v150, v150, v62
    v_max_f32 v151, v151, v63
    v_pk_add_f32 v[148:149], v[148:149], s[58:59]
    v_cvt_pk_bf16_f32 v169, v146, v147
    v_pk_fma_f32 v[60:61], v[156:157], s[56:57], v[18:19]
    v_exp_f32_e64 v58, v58 clamp
    v_exp_f32_e64 v59, v59 clamp
    v_max_f32 v152, v152, v56
    v_max_f32 v153, v153, v57
    v_pk_add_f32 v[150:151], v[150:151], s[58:59]
    v_cvt_pk_bf16_f32 v170, v148, v149
    v_pk_fma_f32 v[62:63], v[158:159], s[56:57], v[18:19]
    v_exp_f32_e64 v60, v60 clamp
    v_exp_f32_e64 v61, v61 clamp
    v_max_f32 v154, v154, v58
    v_max_f32 v155, v155, v59
    v_pk_add_f32 v[152:153], v[152:153], s[58:59]
    v_cvt_pk_bf16_f32 v171, v150, v151
    v_exp_f32_e64 v62, v62 clamp
    v_exp_f32_e64 v63, v63 clamp
    v_max_f32 v156, v156, v60
    v_max_f32 v157, v157, v61
    v_pk_add_f32 v[154:155], v[154:155], s[58:59]
    v_cvt_pk_bf16_f32 v172, v152, v153
    v_max_f32 v158, v158, v62
    v_max_f32 v159, v159, v63
    v_pk_add_f32 v[156:157], v[156:157], s[58:59]
    v_cvt_pk_bf16_f32 v173, v154, v155
    v_pk_add_f32 v[158:159], v[158:159], s[58:59]
    v_cvt_pk_bf16_f32 v174, v156, v157
    v_cvt_pk_bf16_f32 v175, v158, v159
    global_store_dwordx4 v16, v[168:171], s[34:35] sc1
    global_store_dwordx4 v16, v[172:175], s[34:35] offset:1024 sc1
    s_setprio 0
    v_add_u32 v238, 0x10000, v238
    s_lshl_b32 s9, s47, 1
    s_and_b32 s10, s44, 1
    s_add_u32 s9, s9, s10
    s_mul_i32 s9, s9, 3840
    s_lshl_b32 s10, s48, 7
    s_add_u32 s9, s9, s10
    s_and_b32 s10, s44, 2
    s_lshl_b32 s10, s10, 1
    s_add_u32 s9, s9, s10
    s_add_u32 s15, s9, 4261376
    s_mov_b32 s9, 0x01010101
    v_cmp_ne_u32 vcc, s9, v203
    s_cbranch_vccz Lgk_1
    v_and_b32 v20, 7, v1
    v_lshlrev_b32 v20, 2, v20
    s_mov_b32 s10, 0
    s_mov_b32 s9, 0x01010101
Lg_2:
    global_load_dword v21, v20, s[32:33] sc1
    s_add_u32 s10, s10, 1
    s_waitcnt vmcnt(0)
    v_cmp_ne_u32 vcc, s9, v21
    s_cmp_gt_u32 s10, 16384
    s_cbranch_scc1 Lg_3
    s_cbranch_vccz Lg_3
    s_sleep 8
    s_branch Lg_2
Lg_3:
Lgk_1:
    s_mov_b32 s14, 1
    s_call_b64 s[100:101], L_setup
    s_nop 0
    s_waitcnt vmcnt(0)
    v_mov_b32 v22, s15
    v_mov_b32 v23, 1
    s_mov_b64 exec, 1
    global_store_dword v22, v23, s[34:35] sc1
    s_mov_b64 exec, -1
    s_barrier
    s_add_u32 m0, s97, 90112
    s_add_u32 s9, s96, 458752
    buffer_load_dwordx4 v253, s[92:95], s9 offen lds
    s_add_u32 m0, s97, 91136
    s_add_u32 s9, s9, 8192
    buffer_load_dwordx4 v253, s[92:95], s9 offen lds
    s_add_u32 m0, s97, 98304
    s_add_u32 s9, s96, 262272
    buffer_load_dwordx4 v253, s[92:95], s9 offen lds
    s_add_u32 m0, s97, 99328
    s_add_u32 s9, s9, 8192
    buffer_load_dwordx4 v253, s[92:95], s9 offen lds
    s_add_u32 m0, s97, 106496
    s_add_u32 s9, s96, 327808
    buffer_load_dwordx4 v253, s[92:95], s9 offen lds
    s_add_u32 m0, s97, 107520
    s_add_u32 s9, s9, 8192
    buffer_load_dwordx4 v253, s[92:95], s9 offen lds
    s_add_u32 m0, s97, 114688
    s_add_u32 s9, s96, 393344
    buffer_load_dwordx4 v253, s[92:95], s9 offen lds
    s_add_u32 m0, s97, 115712
    s_add_u32 s9, s9, 8192
    buffer_load_dwordx4 v253, s[92:95], s9 offen lds
    s_add_u32 m0, s97, 122880
    s_add_u32 s9, s96, 458880
    buffer_load_dwordx4 v253, s[92:95], s9 offen lds
    s_add_u32 m0, s97, 123904
    s_add_u32 s9, s9, 8192
    buffer_load_dwordx4 v253, s[92:95], s9 offen lds
    s_branch L_p2w
L_gA:
    s_nop 4
    v_and_b32 v20, 31, v1
    v_lshrrev_b32 v21, 5, v1
    v_bfe_u32 v22, v1, 1, 3
    v_xor_b32 v22, v22, v21
    s_and_b32 s9, s44, 1
    s_lshl_b32 s9, s9, 13
    v_lshlrev_b32 v20, 7, v20
    v_add_u32 v20, s9, v20
    v_xor_b32 v23, 0, v22
    v_lshl_add_u32 v4, v23, 4, v20
    v_add_u32 v8, 0x10000, v4
    v_xor_b32 v23, 2, v22
    v_lshl_add_u32 v5, v23, 4, v20
    v_add_u32 v9, 0x10000, v5
    v_xor_b32 v23, 4, v22
    v_lshl_add_u32 v6, v23, 4, v20
    v_add_u32 v10, 0x10000, v6
    v_xor_b32 v23, 6, v22
    v_lshl_add_u32 v7, v23, 4, v20
    v_add_u32 v11, 0x10000, v7
    s_lshr_b32 s9, s11, 1
    v_bfe_u32 v20, v1, 2, 2
    v_lshl_add_u32 v22, v21, 3, v20
    v_lshlrev_b32 v22, 7, v22
    v_lshrrev_b32 v20, 1, v20
    v_xor_b32 v20, s9, v20
    v_lshl_add_u32 v22, v20, 6, v22
    v_bfe_u32 v20, v1, 4, 1
    v_lshl_add_u32 v22, v20, 5, v22
    v_and_b32 v20, 3, v1
    v_lshl_add_u32 v22, v20, 3, v22
    v_add_u32 v12, 131072, v22
    v_mov_b32 v201, v22
    v_add_u32 v200, 0x10000, v22
    s_lshl_b32 s9, s47, 2
    s_and_b32 s10, s44, 1
    s_lshl_b32 s10, s10, 1
    s_add_u32 s9, s9, s10
    s_lshl_b32 s9, s9, 5
    s_lshl_b32 s10, s48, 2
    s_add_u32 s9, s9, s10
    s_and_b32 s10, s44, 2
    s_add_u32 s9, s9, s10
    s_lshl_b32 s9, s9, 10
    s_add_u32 s9, s9, 4096
    v_lshlrev_b32 v17, 4, v1
    v_add_u32 v15, s9, v17
    v_add_u32 v16, 0x8000, v15
    s_mov_b32 s56, 0x3fb8aa3b
    s_mov_b32 s57, 0x3fb8aa3b
    s_mov_b32 s58, 0x358637bd
    s_mov_b32 s59, 0x358637bd
    v_mov_b32 v18, 0xbfb8aa3b
    v_mov_b32 v19, 0xbfb8aa3b
    v_and_b32 v20, 16, v1
    v_cmp_eq_u32 s[60:61], 0, v20
    v_mov_b32 v196, 0x3f803f80
    v_mov_b32 v197, 0x3f803f80
    v_mov_b32 v198, 0x3f803f80
    v_mov_b32 v199, 0x3f803f80
    s_lshl_b32 s9, s48, 2
    s_add_u32 s9, s9, s11
    s_mul_i32 s98, s9, 3840
    s_add_u32 s98, s98, 4259840
    v_lshlrev_b32 v13, 2, v1
    v_add_u32 v13, s98, v13
    s_lshl_b32 s9, s48, 2
    s_lshr_b32 s10, s47, 2
    s_add_u32 s9, s9, s10
    s_mul_i32 s99, s9, 3840
    s_and_b32 s10, s47, 3
    s_lshl_b32 s10, s10, 7
    s_add_u32 s99, s99, s10
    s_lshl_b32 s10, s11, 2
    s_add_u32 s99, s99, s10
    s_add_u32 s99, s99, 4263168
    s_waitcnt lgkmcnt(0)
    s_and_b32 s63, s46, 3
    s_lshr_b32 s62, s46, 2
    s_lshl_b32 s62, s62, 1
    s_bfe_u32 s9, s2, 65543
    s_add_u32 s62, s62, s9
    s_lshl_b32 s9, s45, 3
    s_add_u32 s62, s62, s9
    v_lshrrev_b32 v255, 2, v1
    v_and_b32 v255, 4, v255
    v_and_b32 v253, 7, v1
    v_xor_b32 v255, v255, v253
    v_lshlrev_b32 v255, 4, v255
    v_lshl_add_u32 v253, v254, 10, v255
    v_lshrrev_b32 v255, 5, v1
    v_bfe_u32 v237, v1, 2, 2
    v_lshl_add_u32 v238, v255, 2, v237
    v_lshlrev_b32 v238, 7, v238
    v_lshrrev_b32 v237, 1, v237
    s_and_b32 s9, s11, 1
    v_xor_b32 v237, s9, v237
    v_lshl_add_u32 v238, v237, 6, v238
    v_bfe_u32 v237, v1, 4, 1
    v_lshl_add_u32 v238, v237, 5, v238
    v_and_b32 v237, 3, v1
    v_lshl_add_u32 v238, v237, 3, v238
    s_lshr_b32 s9, s11, 1
    s_lshl_b32 s9, s9, 15
    v_add_u32 v238, s9, v238
    s_mov_b32 s14, 0
    s_lshl_b32 s96, s11, 14
    s_lshl_b32 s9, s63, 8
    s_add_u32 s96, s96, s9
    s_mov_b32 s92, s12
    s_and_b32 s93, s13, 0xffff
    s_mov_b32 s94, 524288
    s_mov_b32 s95, 0x00020000
    v_and_b32 v232, 3, v1
    v_lshlrev_b32 v232, 21, v232
    v_add_u32 v232, 4096, v232
    v_cmp_eq_u32 vcc, 4096, v232
    s_nop 1
    v_cndmask_b32 v232, v232, 0, vcc
    v_min_u32 v232, 4227072, v232
    v_or_b32 v233, 0x6000, v232
    v_cmp_lt_u32 vcc, 4194304, v232
    s_nop 1
    v_cndmask_b32 v232, v232, v233, vcc
    global_load_dword v233, v232, s[34:35]
    s_lshl_b32 s9, s62, 15
    s_lshl_b32 s10, s63, 8
    s_add_u32 s9, s9, s10
    v_mov_b32 v234, s9
    global_load_dword v235, v234, s[30:31]
    v_mov_b32 v234, 0
    global_load_dword v236, v234, s[12:13]
    v_and_b32 v202, 7, v1
    v_lshlrev_b32 v202, 2, v202
    s_and_b32 s9, s44, 1
    s_mul_i32 s9, s9, 1280
    s_sub_u32 s9, 17920, s9
    s_add_u32 s9, s9, s97
    v_mov_b32 v204, s9
    s_xor_b32 s10, s44, 1
    s_and_b32 s9, s10, 1
    s_mul_i32 s9, s9, 1280
    s_sub_u32 s9, 17920, s9
    s_lshl_b32 s10, s10, 11
    s_add_u32 s9, s9, s10
    v_mov_b32 v206, s9
    v_mov_b32 v205, 0
    v_mov_b32 v207, 1
    s_barrier
    ds_read_b128 v[24:27], v4 offset:0
    ds_read_b64_tr_b16 v[32:33], v12 offset:0
    ds_read_b64_tr_b16 v[34:35], v12 offset:512
    ds_read_b128 v[28:31], v4 offset:4096
    ds_read_b64_tr_b16 v[36:37], v12 offset:4096
    ds_read_b64_tr_b16 v[38:39], v12 offset:4608
    ds_read_b128 v[40:43], v5 offset:0
    ds_read_b64_tr_b16 v[48:49], v12 offset:2048
    ds_read_b64_tr_b16 v[50:51], v12 offset:2560
    ds_read_b128 v[44:47], v5 offset:4096
    ds_read_b64_tr_b16 v[52:53], v12 offset:6144
    ds_read_b64_tr_b16 v[54:55], v12 offset:6656
    s_waitcnt lgkmcnt(0)
    s_barrier
    v_mfma_f32_32x32x16_bf16 v[64:79], v[24:27], v[32:35], 1.0
    ds_read_b128 v[128:131], v6 offset:0
    ds_read_b64_tr_b16 v[136:137], v12 offset:8192
    v_mfma_f32_32x32x16_bf16 v[96:111], v[28:31], v[32:35], 1.0
    ds_read_b64_tr_b16 v[138:139], v12 offset:8704
    ds_read_b128 v[132:135], v6 offset:4096
    v_mfma_f32_32x32x16_bf16 v[80:95], v[24:27], v[36:39], 0
    ds_read_b64_tr_b16 v[140:141], v12 offset:12288
    ds_read_b64_tr_b16 v[142:143], v12 offset:12800
    v_mfma_f32_32x32x16_bf16 v[112:127], v[28:31], v[36:39], 0
    ds_read_b128 v[144:147], v7 offset:0
    ds_read_b64_tr_b16 v[152:153], v12 offset:10240
    v_mfma_f32_32x32x16_bf16 v[64:79], v[40:43], v[48:51], v[64:79]
    ds_read_b64_tr_b16 v[154:155], v12 offset:10752
    ds_read_b128 v[148:151], v7 offset:4096
    v_mfma_f32_32x32x16_bf16 v[96:111], v[44:47], v[48:51], v[96:111]
    ds_read_b64_tr_b16 v[156:157], v12 offset:14336
    ds_read_b64_tr_b16 v[158:159], v12 offset:14848
    v_mfma_f32_32x32x16_bf16 v[80:95], v[40:43], v[52:55], v[80:95]
    v_mfma_f32_32x32x16_bf16 v[112:127], v[44:47], v[52:55], v[112:127]
    s_waitcnt lgkmcnt(0)
    s_barrier
    v_mfma_f32_32x32x16_bf16 v[64:79], v[128:131], v[136:139], v[64:79]
    ds_read_b128 v[24:27], v4 offset:16384
    ds_read_b64_tr_b16 v[32:33], v12 offset:16384
    v_mfma_f32_32x32x16_bf16 v[96:111], v[132:135], v[136:139], v[96:111]
    ds_read_b64_tr_b16 v[34:35], v12 offset:16896
    ds_read_b128 v[28:31], v4 offset:20480
    v_mfma_f32_32x32x16_bf16 v[80:95], v[128:131], v[140:143], v[80:95]
    ds_read_b64_tr_b16 v[36:37], v12 offset:20480
    ds_read_b64_tr_b16 v[38:39], v12 offset:20992
    v_mfma_f32_32x32x16_bf16 v[112:127], v[132:135], v[140:143], v[112:127]
    ds_read_b128 v[40:43], v5 offset:16384
    ds_read_b64_tr_b16 v[48:49], v12 offset:18432
    v_mfma_f32_32x32x16_bf16 v[64:79], v[144:147], v[152:155], v[64:79]
    ds_read_b64_tr_b16 v[50:51], v12 offset:18944
    ds_read_b128 v[44:47], v5 offset:20480
    v_mfma_f32_32x32x16_bf16 v[96:111], v[148:151], v[152:155], v[96:111]
    ds_read_b64_tr_b16 v[52:53], v12 offset:22528
    ds_read_b64_tr_b16 v[54:55], v12 offset:23040
    v_mfma_f32_32x32x16_bf16 v[80:95], v[144:147], v[156:159], v[80:95]
    v_mfma_f32_32x32x16_bf16 v[112:127], v[148:151], v[156:159], v[112:127]
    s_waitcnt lgkmcnt(0)
    s_barrier
    v_mfma_f32_32x32x16_bf16 v[64:79], v[24:27], v[32:35], v[64:79]
    ds_read_b128 v[128:131], v6 offset:16384
    ds_read_b64_tr_b16 v[136:137], v12 offset:24576
    v_mfma_f32_32x32x16_bf16 v[96:111], v[28:31], v[32:35], v[96:111]
    ds_read_b64_tr_b16 v[138:139], v12 offset:25088
    ds_read_b128 v[132:135], v6 offset:20480
    v_mfma_f32_32x32x16_bf16 v[80:95], v[24:27], v[36:39], v[80:95]
    ds_read_b64_tr_b16 v[140:141], v12 offset:28672
    ds_read_b64_tr_b16 v[142:143], v12 offset:29184
    v_mfma_f32_32x32x16_bf16 v[112:127], v[28:31], v[36:39], v[112:127]
    ds_read_b128 v[144:147], v7 offset:16384
    ds_read_b64_tr_b16 v[152:153], v12 offset:26624
    v_mfma_f32_32x32x16_bf16 v[64:79], v[40:43], v[48:51], v[64:79]
    ds_read_b64_tr_b16 v[154:155], v12 offset:27136
    ds_read_b128 v[148:151], v7 offset:20480
    v_mfma_f32_32x32x16_bf16 v[96:111], v[44:47], v[48:51], v[96:111]
    ds_read_b64_tr_b16 v[156:157], v12 offset:30720
    ds_read_b64_tr_b16 v[158:159], v12 offset:31232
    v_mfma_f32_32x32x16_bf16 v[80:95], v[40:43], v[52:55], v[80:95]
    v_mfma_f32_32x32x16_bf16 v[112:127], v[44:47], v[52:55], v[112:127]
    s_waitcnt lgkmcnt(0)
    s_barrier
    v_mfma_f32_32x32x16_bf16 v[64:79], v[128:131], v[136:139], v[64:79]
    ds_read_b128 v[24:27], v4 offset:32768
    ds_read_b64_tr_b16 v[32:33], v12 offset:0
    v_mfma_f32_32x32x16_bf16 v[96:111], v[132:135], v[136:139], v[96:111]
    ds_read_b64_tr_b16 v[34:35], v12 offset:512
    ds_read_b128 v[28:31], v4 offset:36864
    v_mfma_f32_32x32x16_bf16 v[80:95], v[128:131], v[140:143], v[80:95]
    ds_read_b64_tr_b16 v[36:37], v12 offset:4096
    ds_read_b64_tr_b16 v[38:39], v12 offset:4608
    v_mfma_f32_32x32x16_bf16 v[112:127], v[132:135], v[140:143], v[112:127]
    ds_read_b128 v[40:43], v5 offset:32768
    ds_read_b64_tr_b16 v[48:49], v12 offset:2048
    v_mfma_f32_32x32x16_bf16 v[64:79], v[144:147], v[152:155], v[64:79]
    ds_read_b64_tr_b16 v[50:51], v12 offset:2560
    ds_read_b128 v[44:47], v5 offset:36864
    v_mfma_f32_32x32x16_bf16 v[96:111], v[148:151], v[152:155], v[96:111]
    ds_read_b64_tr_b16 v[52:53], v12 offset:6144
    ds_read_b64_tr_b16 v[54:55], v12 offset:6656
    v_mfma_f32_32x32x16_bf16 v[80:95], v[144:147], v[156:159], v[80:95]
    v_mfma_f32_32x32x16_bf16 v[112:127], v[148:151], v[156:159], v[112:127]
    s_waitcnt lgkmcnt(0)
    s_barrier
    v_mfma_f32_32x32x16_bf16 v[64:79], v[24:27], v[32:35], v[64:79]
    ds_read_b128 v[128:131], v6 offset:32768
    ds_read_b64_tr_b16 v[136:137], v12 offset:8192
    v_mfma_f32_32x32x16_bf16 v[96:111], v[28:31], v[32:35], v[96:111]
    ds_read_b64_tr_b16 v[138:139], v12 offset:8704
    ds_read_b128 v[132:135], v6 offset:36864
    v_mfma_f32_32x32x16_bf16 v[80:95], v[24:27], v[36:39], v[80:95]
    ds_read_b64_tr_b16 v[140:141], v12 offset:12288
    ds_read_b64_tr_b16 v[142:143], v12 offset:12800
    v_mfma_f32_32x32x16_bf16 v[112:127], v[28:31], v[36:39], v[112:127]
    ds_read_b128 v[144:147], v7 offset:32768
    ds_read_b64_tr_b16 v[152:153], v12 offset:10240
    v_mfma_f32_32x32x16_bf16 v[64:79], v[40:43], v[48:51], v[64:79]
    ds_read_b64_tr_b16 v[154:155], v12 offset:10752
    ds_read_b128 v[148:151], v7 offset:36864
    v_mfma_f32_32x32x16_bf16 v[96:111], v[44:47], v[48:51], v[96:111]
    ds_read_b64_tr_b16 v[156:157], v12 offset:14336
    ds_read_b64_tr_b16 v[158:159], v12 offset:14848
    v_mfma_f32_32x32x16_bf16 v[80:95], v[40:43], v[52:55], v[80:95]
    v_mfma_f32_32x32x16_bf16 v[112:127], v[44:47], v[52:55], v[112:127]
    s_waitcnt lgkmcnt(0)
    s_barrier
    v_mfma_f32_32x32x16_bf16 v[64:79], v[128:131], v[136:139], v[64:79]
    ds_read_b128 v[24:27], v4 offset:49152
    ds_read_b64_tr_b16 v[32:33], v12 offset:16384
    v_mfma_f32_32x32x16_bf16 v[96:111], v[132:135], v[136:139], v[96:111]
    ds_read_b64_tr_b16 v[34:35], v12 offset:16896
    ds_read_b128 v[28:31], v4 offset:53248
    v_mfma_f32_32x32x16_bf16 v[80:95], v[128:131], v[140:143], v[80:95]
    ds_read_b64_tr_b16 v[36:37], v12 offset:20480
    ds_read_b64_tr_b16 v[38:39], v12 offset:20992
    v_mfma_f32_32x32x16_bf16 v[112:127], v[132:135], v[140:143], v[112:127]
    ds_read_b128 v[40:43], v5 offset:49152
    ds_read_b64_tr_b16 v[48:49], v12 offset:18432
    v_mfma_f32_32x32x16_bf16 v[64:79], v[144:147], v[152:155], v[64:79]
    ds_read_b64_tr_b16 v[50:51], v12 offset:18944
    ds_read_b128 v[44:47], v5 offset:53248
    v_mfma_f32_32x32x16_bf16 v[96:111], v[148:151], v[152:155], v[96:111]
    ds_read_b64_tr_b16 v[52:53], v12 offset:22528
    ds_read_b64_tr_b16 v[54:55], v12 offset:23040
    v_mfma_f32_32x32x16_bf16 v[80:95], v[144:147], v[156:159], v[80:95]
    v_mfma_f32_32x32x16_bf16 v[112:127], v[148:151], v[156:159], v[112:127]
    s_waitcnt lgkmcnt(0)
    s_barrier
    v_mfma_f32_32x32x16_bf16 v[64:79], v[24:27], v[32:35], v[64:79]
    ds_read_b128 v[128:131], v6 offset:49152
    ds_read_b64_tr_b16 v[136:137], v12 offset:24576
    v_mfma_f32_32x32x16_bf16 v[96:111], v[28:31], v[32:35], v[96:111]
    ds_read_b64_tr_b16 v[138:139], v12 offset:25088
    ds_read_b128 v[132:135], v6 offset:53248
    v_mfma_f32_32x32x16_bf16 v[80:95], v[24:27], v[36:39], v[80:95]
    ds_read_b64_tr_b16 v[140:141], v12 offset:28672
    ds_read_b64_tr_b16 v[142:143], v12 offset:29184
    v_mfma_f32_32x32x16_bf16 v[112:127], v[28:31], v[36:39], v[112:127]
    ds_read_b128 v[144:147], v7 offset:49152
    ds_read_b64_tr_b16 v[152:153], v12 offset:26624
    v_mfma_f32_32x32x16_bf16 v[64:79], v[40:43], v[48:51], v[64:79]
    ds_read_b64_tr_b16 v[154:155], v12 offset:27136
    ds_read_b128 v[148:151], v7 offset:53248
    v_mfma_f32_32x32x16_bf16 v[96:111], v[44:47], v[48:51], v[96:111]
    ds_read_b64_tr_b16 v[156:157], v12 offset:30720
    ds_read_b64_tr_b16 v[158:159], v12 offset:31232
    v_mfma_f32_32x32x16_bf16 v[80:95], v[40:43], v[52:55], v[80:95]
    v_mfma_f32_32x32x16_bf16 v[112:127], v[44:47], v[52:55], v[112:127]
    s_waitcnt lgkmcnt(0)
    s_barrier
    v_mfma_f32_32x32x16_bf16 v[64:79], v[128:131], v[136:139], v[64:79]
    ds_read_b128 v[24:27], v8 offset:0
    ds_read_b64_tr_b16 v[32:33], v12 offset:0
    v_mfma_f32_32x32x16_bf16 v[96:111], v[132:135], v[136:139], v[96:111]
    ds_read_b64_tr_b16 v[34:35], v12 offset:512
    ds_read_b128 v[28:31], v8 offset:4096
    v_mfma_f32_32x32x16_bf16 v[80:95], v[128:131], v[140:143], v[80:95]
    ds_read_b64_tr_b16 v[36:37], v12 offset:4096
    ds_read_b64_tr_b16 v[38:39], v12 offset:4608
    v_mfma_f32_32x32x16_bf16 v[112:127], v[132:135], v[140:143], v[112:127]
    ds_read_b128 v[40:43], v9 offset:0
    ds_read_b64_tr_b16 v[48:49], v12 offset:2048
    v_mfma_f32_32x32x16_bf16 v[64:79], v[144:147], v[152:155], v[64:79]
    ds_read_b64_tr_b16 v[50:51], v12 offset:2560
    ds_read_b128 v[44:47], v9 offset:4096
    v_mfma_f32_32x32x16_bf16 v[96:111], v[148:151], v[152:155], v[96:111]
    ds_read_b64_tr_b16 v[52:53], v12 offset:6144
    ds_read_b64_tr_b16 v[54:55], v12 offset:6656
    v_mfma_f32_32x32x16_bf16 v[80:95], v[144:147], v[156:159], v[80:95]
    v_mfma_f32_32x32x16_bf16 v[112:127], v[148:151], v[156:159], v[112:127]
    s_waitcnt lgkmcnt(0)
    s_barrier
    v_mfma_f32_32x32x16_bf16 v[64:79], v[24:27], v[32:35], v[64:79]
    ds_read_b128 v[128:131], v10 offset:0
    ds_read_b64_tr_b16 v[136:137], v12 offset:8192
    v_mfma_f32_32x32x16_bf16 v[96:111], v[28:31], v[32:35], v[96:111]
    ds_read_b64_tr_b16 v[138:139], v12 offset:8704
    ds_read_b128 v[132:135], v10 offset:4096
    v_mfma_f32_32x32x16_bf16 v[80:95], v[24:27], v[36:39], v[80:95]
    ds_read_b64_tr_b16 v[140:141], v12 offset:12288
    ds_read_b64_tr_b16 v[142:143], v12 offset:12800
    v_mfma_f32_32x32x16_bf16 v[112:127], v[28:31], v[36:39], v[112:127]
    ds_read_b128 v[144:147], v11 offset:0
    ds_read_b64_tr_b16 v[152:153], v12 offset:10240
    v_mfma_f32_32x32x16_bf16 v[64:79], v[40:43], v[48:51], v[64:79]
    ds_read_b64_tr_b16 v[154:155], v12 offset:10752
    ds_read_b128 v[148:151], v11 offset:4096
    v_mfma_f32_32x32x16_bf16 v[96:111], v[44:47], v[48:51], v[96:111]
    ds_read_b64_tr_b16 v[156:157], v12 offset:14336
    ds_read_b64_tr_b16 v[158:159], v12 offset:14848
    v_mfma_f32_32x32x16_bf16 v[80:95], v[40:43], v[52:55], v[80:95]
    v_mfma_f32_32x32x16_bf16 v[112:127], v[44:47], v[52:55], v[112:127]
    s_waitcnt lgkmcnt(0)
    s_barrier
    v_mfma_f32_32x32x16_bf16 v[64:79], v[128:131], v[136:139], v[64:79]
    ds_read_b128 v[24:27], v8 offset:16384
    ds_read_b64_tr_b16 v[32:33], v12 offset:16384
    v_mfma_f32_32x32x16_bf16 v[96:111], v[132:135], v[136:139], v[96:111]
    ds_read_b64_tr_b16 v[34:35], v12 offset:16896
    ds_read_b128 v[28:31], v8 offset:20480
    v_mfma_f32_32x32x16_bf16 v[80:95], v[128:131], v[140:143], v[80:95]
    ds_read_b64_tr_b16 v[36:37], v12 offset:20480
    ds_read_b64_tr_b16 v[38:39], v12 offset:20992
    v_mfma_f32_32x32x16_bf16 v[112:127], v[132:135], v[140:143], v[112:127]
    ds_read_b128 v[40:43], v9 offset:16384
    ds_read_b64_tr_b16 v[48:49], v12 offset:18432
    v_mfma_f32_32x32x16_bf16 v[64:79], v[144:147], v[152:155], v[64:79]
    ds_read_b64_tr_b16 v[50:51], v12 offset:18944
    ds_read_b128 v[44:47], v9 offset:20480
    v_mfma_f32_32x32x16_bf16 v[96:111], v[148:151], v[152:155], v[96:111]
    ds_read_b64_tr_b16 v[52:53], v12 offset:22528
    ds_read_b64_tr_b16 v[54:55], v12 offset:23040
    v_mfma_f32_32x32x16_bf16 v[80:95], v[144:147], v[156:159], v[80:95]
    v_mfma_f32_32x32x16_bf16 v[112:127], v[148:151], v[156:159], v[112:127]
    s_waitcnt lgkmcnt(0)
    s_barrier
    v_mfma_f32_32x32x16_bf16 v[64:79], v[24:27], v[32:35], v[64:79]
    ds_read_b128 v[128:131], v10 offset:16384
    ds_read_b64_tr_b16 v[136:137], v12 offset:24576
    v_mfma_f32_32x32x16_bf16 v[96:111], v[28:31], v[32:35], v[96:111]
    ds_read_b64_tr_b16 v[138:139], v12 offset:25088
    ds_read_b128 v[132:135], v10 offset:20480
    v_mfma_f32_32x32x16_bf16 v[80:95], v[24:27], v[36:39], v[80:95]
    ds_read_b64_tr_b16 v[140:141], v12 offset:28672
    ds_read_b64_tr_b16 v[142:143], v12 offset:29184
    v_mfma_f32_32x32x16_bf16 v[112:127], v[28:31], v[36:39], v[112:127]
    ds_read_b128 v[144:147], v11 offset:16384
    ds_read_b64_tr_b16 v[152:153], v12 offset:26624
    v_mfma_f32_32x32x16_bf16 v[64:79], v[40:43], v[48:51], v[64:79]
    ds_read_b64_tr_b16 v[154:155], v12 offset:27136
    ds_read_b128 v[148:151], v11 offset:20480
    v_mfma_f32_32x32x16_bf16 v[96:111], v[44:47], v[48:51], v[96:111]
    ds_read_b64_tr_b16 v[156:157], v12 offset:30720
    ds_read_b64_tr_b16 v[158:159], v12 offset:31232
    v_mfma_f32_32x32x16_bf16 v[80:95], v[40:43], v[52:55], v[80:95]
    v_mfma_f32_32x32x16_bf16 v[112:127], v[44:47], v[52:55], v[112:127]
    s_waitcnt lgkmcnt(0)
    s_barrier
    v_mfma_f32_32x32x16_bf16 v[64:79], v[128:131], v[136:139], v[64:79]
    ds_read_b128 v[24:27], v8 offset:32768
    ds_read_b64_tr_b16 v[32:33], v12 offset:0
    v_mfma_f32_32x32x16_bf16 v[96:111], v[132:135], v[136:139], v[96:111]
    ds_read_b64_tr_b16 v[34:35], v12 offset:512
    ds_read_b128 v[28:31], v8 offset:36864
    v_mfma_f32_32x32x16_bf16 v[80:95], v[128:131], v[140:143], v[80:95]
    ds_read_b64_tr_b16 v[36:37], v12 offset:4096
    ds_read_b64_tr_b16 v[38:39], v12 offset:4608
    v_mfma_f32_32x32x16_bf16 v[112:127], v[132:135], v[140:143], v[112:127]
    ds_read_b128 v[40:43], v9 offset:32768
    ds_read_b64_tr_b16 v[48:49], v12 offset:2048
    v_mfma_f32_32x32x16_bf16 v[64:79], v[144:147], v[152:155], v[64:79]
    ds_read_b64_tr_b16 v[50:51], v12 offset:2560
    ds_read_b128 v[44:47], v9 offset:36864
    v_mfma_f32_32x32x16_bf16 v[96:111], v[148:151], v[152:155], v[96:111]
    ds_read_b64_tr_b16 v[52:53], v12 offset:6144
    ds_read_b64_tr_b16 v[54:55], v12 offset:6656
    v_mfma_f32_32x32x16_bf16 v[80:95], v[144:147], v[156:159], v[80:95]
    global_load_dword v203, v202, s[32:33] sc1
    v_mfma_f32_32x32x16_bf16 v[112:127], v[148:151], v[156:159], v[112:127]
    s_waitcnt lgkmcnt(0)
    s_barrier
    v_mfma_f32_32x32x16_bf16 v[64:79], v[24:27], v[32:35], v[64:79]
    ds_read_b128 v[128:131], v10 offset:32768
    ds_read_b64_tr_b16 v[136:137], v12 offset:8192
    v_mfma_f32_32x32x16_bf16 v[96:111], v[28:31], v[32:35], v[96:111]
    ds_read_b64_tr_b16 v[138:139], v12 offset:8704
    ds_read_b128 v[132:135], v10 offset:36864
    v_mfma_f32_32x32x16_bf16 v[80:95], v[24:27], v[36:39], v[80:95]
    ds_read_b64_tr_b16 v[140:141], v12 offset:12288
    ds_read_b64_tr_b16 v[142:143], v12 offset:12800
    v_mfma_f32_32x32x16_bf16 v[112:127], v[28:31], v[36:39], v[112:127]
    ds_read_b128 v[144:147], v11 offset:32768
    ds_read_b64_tr_b16 v[152:153], v12 offset:10240
    v_mfma_f32_32x32x16_bf16 v[64:79], v[40:43], v[48:51], v[64:79]
    ds_read_b64_tr_b16 v[154:155], v12 offset:10752
    ds_read_b128 v[148:151], v11 offset:36864
    v_mfma_f32_32x32x16_bf16 v[96:111], v[44:47], v[48:51], v[96:111]
    ds_read_b64_tr_b16 v[156:157], v12 offset:14336
    ds_read_b64_tr_b16 v[158:159], v12 offset:14848
    v_mfma_f32_32x32x16_bf16 v[80:95], v[40:43], v[52:55], v[80:95]
    ds_write_b32 v204, v205
    v_mfma_f32_32x32x16_bf16 v[112:127], v[44:47], v[52:55], v[112:127]
    s_waitcnt lgkmcnt(0)
    s_barrier
    v_mfma_f32_32x32x16_bf16 v[64:79], v[128:131], v[136:139], v[64:79]
    ds_read_b128 v[24:27], v8 offset:49152
    ds_read_b64_tr_b16 v[32:33], v12 offset:16384
    v_mfma_f32_32x32x16_bf16 v[96:111], v[132:135], v[136:139], v[96:111]
    ds_read_b64_tr_b16 v[34:35], v12 offset:16896
    ds_read_b128 v[28:31], v8 offset:53248
    v_mfma_f32_32x32x16_bf16 v[80:95], v[128:131], v[140:143], v[80:95]
    ds_read_b64_tr_b16 v[36:37], v12 offset:20480
    ds_read_b64_tr_b16 v[38:39], v12 offset:20992
    v_mfma_f32_32x32x16_bf16 v[112:127], v[132:135], v[140:143], v[112:127]
    ds_read_b128 v[40:43], v9 offset:49152
    ds_read_b64_tr_b16 v[48:49], v12 offset:18432
    v_mfma_f32_32x32x16_bf16 v[64:79], v[144:147], v[152:155], v[64:79]
    ds_read_b64_tr_b16 v[50:51], v12 offset:18944
    ds_read_b128 v[44:47], v9 offset:53248
    v_mfma_f32_32x32x16_bf16 v[96:111], v[148:151], v[152:155], v[96:111]
    ds_read_b64_tr_b16 v[52:53], v12 offset:22528
    ds_read_b64_tr_b16 v[54:55], v12 offset:23040
    v_mfma_f32_32x32x16_bf16 v[80:95], v[144:147], v[156:159], v[80:95]
    v_mfma_f32_32x32x16_bf16 v[112:127], v[148:151], v[156:159], v[112:127]
    s_waitcnt lgkmcnt(0)
    s_barrier
    v_mfma_f32_32x32x16_bf16 v[64:79], v[24:27], v[32:35], v[64:79]
    ds_read_b128 v[128:131], v10 offset:49152
    ds_read_b64_tr_b16 v[136:137], v12 offset:24576
    v_mfma_f32_32x32x16_bf16 v[96:111], v[28:31], v[32:35], v[96:111]
    ds_read_b64_tr_b16 v[138:139], v12 offset:25088
    ds_read_b128 v[132:135], v10 offset:53248
    v_mfma_f32_32x32x16_bf16 v[80:95], v[24:27], v[36:39], v[80:95]
    ds_read_b64_tr_b16 v[140:141], v12 offset:28672
    ds_read_b64_tr_b16 v[142:143], v12 offset:29184
    v_mfma_f32_32x32x16_bf16 v[112:127], v[28:31], v[36:39], v[112:127]
    ds_read_b128 v[144:147], v11 offset:49152
    ds_read_b64_tr_b16 v[152:153], v12 offset:26624
    v_mfma_f32_32x32x16_bf16 v[64:79], v[40:43], v[48:51], v[64:79]
    ds_read_b64_tr_b16 v[154:155], v12 offset:27136
    ds_read_b128 v[148:151], v11 offset:53248
    v_mfma_f32_32x32x16_bf16 v[96:111], v[44:47], v[48:51], v[96:111]
    ds_read_b64_tr_b16 v[156:157], v12 offset:30720
    ds_read_b64_tr_b16 v[158:159], v12 offset:31232
    v_mfma_f32_32x32x16_bf16 v[80:95], v[40:43], v[52:55], v[80:95]
    v_mfma_f32_32x32x16_bf16 v[112:127], v[44:47], v[52:55], v[112:127]
    s_waitcnt lgkmcnt(0)
    s_setprio 3
    s_barrier
    v_mfma_f32_32x32x16_bf16 v[64:79], v[128:131], v[136:139], v[64:79]
    v_mfma_f32_32x32x16_bf16 v[96:111], v[132:135], v[136:139], v[96:111]
    v_mfma_f32_32x32x16_bf16 v[80:95], v[128:131], v[140:143], v[80:95]
    v_mfma_f32_32x32x16_bf16 v[112:127], v[132:135], v[140:143], v[112:127]
    v_mfma_f32_32x32x16_bf16 v[64:79], v[144:147], v[152:155], v[64:79]
    v_mfma_f32_32x32x16_bf16 v[96:111], v[148:151], v[152:155], v[96:111]
    v_mfma_f32_32x32x16_bf16 v[80:95], v[144:147], v[156:159], v[80:95]
    v_mfma_f32_32x32x16_bf16 v[112:127], v[148:151], v[156:159], v[112:127]
    s_setprio 0
    v_and_b32 v25, 31, v1
    v_lshlrev_b32 v25, 6, v25
    v_lshrrev_b32 v24, 5, v1
    v_lshl_add_u32 v25, v24, 5, v25
    s_and_b32 s9, s44, 1
    s_lshl_b32 s10, s9, 13
    s_mul_i32 s9, s9, 960
    s_add_u32 s9, s9, s97
    s_add_u32 s9, s9, 16384
    v_lshlrev_b32 v24, 2, v1
    v_add_u32 v24, s9, v24
    s_and_b32 s9, s44, 2
    s_lshl_b32 s9, s9, 11
    s_add_u32 s9, s9, s10
    s_add_u32 s9, s9, 16384
    v_add_u32 v25, s9, v25
    v_fma_f32 v56, v64, s56, v18
    v_fma_f32 v57, v65, s56, v18
    v_fma_f32 v58, v66, s56, v18
    v_fma_f32 v59, v67, s56, v18
    v_exp_f32_e64 v56, v56 clamp
    v_exp_f32_e64 v57, v57 clamp
    v_fma_f32 v60, v68, s56, v18
    v_fma_f32 v61, v69, s56, v18
    v_exp_f32_e64 v58, v58 clamp
    v_exp_f32_e64 v59, v59 clamp
    v_max_f32 v64, v64, v56
    v_max_f32 v65, v65, v57
    v_fma_f32 v62, v70, s56, v18
    v_fma_f32 v63, v71, s56, v18
    v_exp_f32_e64 v60, v60 clamp
    v_exp_f32_e64 v61, v61 clamp
    v_max_f32 v66, v66, v58
    v_max_f32 v67, v67, v59
    v_add_f32 v64, s58, v64
    v_add_f32 v65, s58, v65
    v_fma_f32 v56, v72, s56, v18
    v_fma_f32 v57, v73, s56, v18
    v_exp_f32_e64 v62, v62 clamp
    v_exp_f32_e64 v63, v63 clamp
    v_max_f32 v68, v68, v60
    v_max_f32 v69, v69, v61
    v_add_f32 v66, s58, v66
    v_add_f32 v67, s58, v67
    v_cvt_pk_bf16_f32 v160, v64, v65
    v_cvt_pk_bf16_f32 v176, v80, v81
    v_fma_f32 v58, v74, s56, v18
    v_fma_f32 v59, v75, s56, v18
    v_exp_f32_e64 v56, v56 clamp
    v_exp_f32_e64 v57, v57 clamp
    v_max_f32 v70, v70, v62
    v_max_f32 v71, v71, v63
    v_add_f32 v68, s58, v68
    v_add_f32 v69, s58, v69
    v_cvt_pk_bf16_f32 v161, v66, v67
    v_cvt_pk_bf16_f32 v177, v82, v83
    v_fma_f32 v60, v76, s56, v18
    v_fma_f32 v61, v77, s56, v18
    v_exp_f32_e64 v58, v58 clamp
    v_exp_f32_e64 v59, v59 clamp
    v_max_f32 v72, v72, v56
    v_max_f32 v73, v73, v57
    v_add_f32 v70, s58, v70
    v_add_f32 v71, s58, v71
    v_cvt_pk_bf16_f32 v162, v68, v69
    v_cvt_pk_bf16_f32 v178, v84, v85
    v_fma_f32 v62, v78, s56, v18
    v_fma_f32 v63, v79, s56, v18
    v_exp_f32_e64 v60, v60 clamp
    v_exp_f32_e64 v61, v61 clamp
    v_max_f32 v74, v74, v58
    v_max_f32 v75, v75, v59
    v_add_f32 v72, s58, v72
    v_add_f32 v73, s58, v73
    v_cvt_pk_bf16_f32 v163, v70, v71
    v_cvt_pk_bf16_f32 v179, v86, v87
    v_exp_f32_e64 v62, v62 clamp
    v_exp_f32_e64 v63, v63 clamp
    s_setprio 3
    v_mfma_f32_32x32x16_bf16 v[128:143], v[160:163], v[176:179], 0
    s_setprio 0
    v_max_f32 v76, v76, v60
    v_max_f32 v77, v77, v61
    v_add_f32 v74, s58, v74
    v_add_f32 v75, s58, v75
    v_cvt_pk_bf16_f32 v164, v72, v73
    s_setprio 3
    v_mfma_f32_32x32x16_bf16 v[144:159], v[160:163], v[196:199], 0
    s_setprio 0
    v_cvt_pk_bf16_f32 v180, v88, v89
    v_max_f32 v78, v78, v62
    v_max_f32 v79, v79, v63
    v_add_f32 v76, s58, v76
    v_add_f32 v77, s58, v77
    v_cvt_pk_bf16_f32 v165, v74, v75
    v_cvt_pk_bf16_f32 v181, v90, v91
    v_add_f32 v78, s58, v78
    v_add_f32 v79, s58, v79
    v_cvt_pk_bf16_f32 v166, v76, v77
    v_cvt_pk_bf16_f32 v182, v92, v93
    v_cvt_pk_bf16_f32 v167, v78, v79
    v_cvt_pk_bf16_f32 v183, v94, v95
    v_fma_f32 v56, v96, s56, v18
    v_fma_f32 v57, v97, s56, v18
    s_setprio 3
    v_mfma_f32_32x32x16_bf16 v[128:143], v[164:167], v[180:183], v[128:143]
    s_setprio 0
    v_fma_f32 v58, v98, s56, v18
    v_fma_f32 v59, v99, s56, v18
    v_exp_f32_e64 v56, v56 clamp
    v_exp_f32_e64 v57, v57 clamp
    v_fma_f32 v60, v100, s56, v18
    s_setprio 3
    v_mfma_f32_32x32x16_bf16 v[144:159], v[164:167], v[196:199], v[144:159]
    s_setprio 0
    v_fma_f32 v61, v101, s56, v18
    v_exp_f32_e64 v58, v58 clamp
    v_exp_f32_e64 v59, v59 clamp
    v_max_f32 v96, v96, v56
    v_max_f32 v97, v97, v57
    v_fma_f32 v62, v102, s56, v18
    v_fma_f32 v63, v103, s56, v18
    v_exp_f32_e64 v60, v60 clamp
    v_exp_f32_e64 v61, v61 clamp
    v_max_f32 v98, v98, v58
    v_max_f32 v99, v99, v59
    v_add_f32 v96, s58, v96
    v_add_f32 v97, s58, v97
    v_fma_f32 v56, v104, s56, v18
    v_fma_f32 v57, v105, s56, v18
    v_exp_f32_e64 v62, v62 clamp
    v_exp_f32_e64 v63, v63 clamp
    v_max_f32 v100, v100, v60
    v_max_f32 v101, v101, v61
    v_add_f32 v98, s58, v98
    v_add_f32 v99, s58, v99
    v_cvt_pk_bf16_f32 v168, v96, v97
    v_cvt_pk_bf16_f32 v184, v112, v113
    v_fma_f32 v58, v106, s56, v18
    v_fma_f32 v59, v107, s56, v18
    v_exp_f32_e64 v56, v56 clamp
    v_exp_f32_e64 v57, v57 clamp
    v_max_f32 v102, v102, v62
    v_max_f32 v103, v103, v63
    v_add_f32 v100, s58, v100
    v_add_f32 v101, s58, v101
    v_cvt_pk_bf16_f32 v169, v98, v99
    v_cvt_pk_bf16_f32 v185, v114, v115
    v_fma_f32 v60, v108, s56, v18
    v_fma_f32 v61, v109, s56, v18
    v_exp_f32_e64 v58, v58 clamp
    v_exp_f32_e64 v59, v59 clamp
    v_max_f32 v104, v104, v56
    v_max_f32 v105, v105, v57
    v_add_f32 v102, s58, v102
    v_add_f32 v103, s58, v103
    v_cvt_pk_bf16_f32 v170, v100, v101
    v_cvt_pk_bf16_f32 v186, v116, v117
    v_fma_f32 v62, v110, s56, v18
    v_fma_f32 v63, v111, s56, v18
    v_exp_f32_e64 v60, v60 clamp
    v_exp_f32_e64 v61, v61 clamp
    v_max_f32 v106, v106, v58
    v_max_f32 v107, v107, v59
    v_add_f32 v104, s58, v104
    v_add_f32 v105, s58, v105
    v_cvt_pk_bf16_f32 v171, v102, v103
    v_cvt_pk_bf16_f32 v187, v118, v119
    v_exp_f32_e64 v62, v62 clamp
    v_exp_f32_e64 v63, v63 clamp
    s_setprio 3
    v_mfma_f32_32x32x16_bf16 v[128:143], v[168:171], v[184:187], v[128:143]
    s_setprio 0
    v_max_f32 v108, v108, v60
    v_max_f32 v109, v109, v61
    v_add_f32 v106, s58, v106
    v_add_f32 v107, s58, v107
    v_cvt_pk_bf16_f32 v172, v104, v105
    s_setprio 3
    v_mfma_f32_32x32x16_bf16 v[144:159], v[168:171], v[196:199], v[144:159]
    s_setprio 0
    v_cvt_pk_bf16_f32 v188, v120, v121
    v_max_f32 v110, v110, v62
    v_max_f32 v111, v111, v63
    v_add_f32 v108, s58, v108
    v_add_f32 v109, s58, v109
    v_cvt_pk_bf16_f32 v173, v106, v107
    v_cvt_pk_bf16_f32 v189, v122, v123
    v_add_f32 v110, s58, v110
    v_add_f32 v111, s58, v111
    v_cvt_pk_bf16_f32 v174, v108, v109
    v_cvt_pk_bf16_f32 v190, v124, v125
    v_cvt_pk_bf16_f32 v175, v110, v111
    v_cvt_pk_bf16_f32 v191, v126, v127
    s_setprio 3
    s_nop 0
    v_mfma_f32_32x32x16_bf16 v[128:143], v[172:175], v[188:191], v[128:143]
    s_setprio 0
    s_setprio 3
    v_mfma_f32_32x32x16_bf16 v[144:159], v[172:175], v[196:199], v[144:159]
    s_setprio 0
    s_nop 10
    v_cndmask_b32 v32, v144, v128, s[60:61]
    v_cndmask_b32 v33, v145, v129, s[60:61]
    v_cndmask_b32 v34, v146, v130, s[60:61]
    v_cndmask_b32 v35, v147, v131, s[60:61]
    v_cndmask_b32 v36, v148, v132, s[60:61]
    v_cndmask_b32 v37, v149, v133, s[60:61]
    v_cndmask_b32 v38, v150, v134, s[60:61]
    v_cndmask_b32 v39, v151, v135, s[60:61]
    v_cndmask_b32 v40, v136, v152, s[60:61]
    v_cndmask_b32 v41, v137, v153, s[60:61]
    v_cndmask_b32 v42, v138, v154, s[60:61]
    v_cndmask_b32 v43, v139, v155, s[60:61]
    v_cndmask_b32 v44, v140, v156, s[60:61]
    v_cndmask_b32 v45, v141, v157, s[60:61]
    v_cndmask_b32 v46, v142, v158, s[60:61]
    v_cndmask_b32 v47, v143, v159, s[60:61]
    s_mov_b32 exec_lo, 0x1ffff
    s_mov_b32 exec_hi, 0x1ffff
    ds_write_b128 v25, v[32:35]
    ds_write_b128 v25, v[36:39] offset:16
    s_mov_b32 exec_lo, 0xffff8000
    s_mov_b32 exec_hi, 0xffff8000
    ds_write_b128 v25, v[40:43] offset:2048
    ds_write_b128 v25, v[44:47] offset:2064
    s_mov_b64 exec, -1
    ds_write_b32 v206, v207
    s_waitcnt vmcnt(0)
    s_mov_b32 s9, 0x01010101
    v_cmp_ne_u32 vcc, s9, v203
    s_cbranch_vccz Lgk_6
    v_and_b32 v20, 7, v1
    v_lshlrev_b32 v20, 2, v20
    s_mov_b32 s10, 0
    s_mov_b32 s9, 0x01010101
Lg_7:
    global_load_dword v21, v20, s[32:33] sc1
    s_add_u32 s10, s10, 1
    s_waitcnt vmcnt(0)
    v_cmp_ne_u32 vcc, s9, v21
    s_cmp_gt_u32 s10, 16384
    s_cbranch_scc1 Lg_8
    s_cbranch_vccz Lg_8
    s_sleep 8
    s_branch Lg_7
Lg_8:
Lgk_6:
    s_mov_b32 s10, 0
Lw_4:
    ds_read_b32 v20, v204
    s_add_u32 s10, s10, 1
    s_waitcnt lgkmcnt(0)
    v_cmp_eq_u32 vcc, 0, v20
    s_cmp_gt_u32 s10, 262144
    s_cbranch_scc1 Lw_5
    s_cbranch_vccnz Lw_4
Lw_5:
    ds_read_b32 v32, v24 offset:0
    ds_read_b32 v40, v24 offset:8192
    ds_read_b32 v33, v24 offset:256
    ds_read_b32 v41, v24 offset:8448
    ds_read_b32 v34, v24 offset:512
    ds_read_b32 v42, v24 offset:8704
    ds_read_b32 v35, v24 offset:768
    ds_read_b32 v43, v24 offset:8960
    ds_read_b32 v36, v24 offset:1024
    ds_read_b32 v44, v24 offset:9216
    s_waitcnt lgkmcnt(8)
    v_add_f32 v32, v32, v40
    global_atomic_add_f32 v13, v32, s[34:35] offset:0 sc1
    s_waitcnt lgkmcnt(6)
    v_add_f32 v33, v33, v41
    global_atomic_add_f32 v13, v33, s[34:35] offset:256 sc1
    s_waitcnt lgkmcnt(4)
    v_add_f32 v34, v34, v42
    global_atomic_add_f32 v13, v34, s[34:35] offset:512 sc1
    s_waitcnt lgkmcnt(2)
    v_add_f32 v35, v35, v43
    global_atomic_add_f32 v13, v35, s[34:35] offset:768 sc1
    s_waitcnt lgkmcnt(0)
    v_add_f32 v36, v36, v44
    s_mov_b64 exec, 0xffff
    global_atomic_add_f32 v13, v36, s[34:35] offset:1024 sc1
    s_mov_b64 exec, -1
    s_setprio 0
    s_add_u32 m0, s97, 16384
    s_add_u32 s9, s96, 131072
    buffer_load_dwordx4 v253, s[92:95], s9 offen lds
    s_add_u32 m0, s97, 17408
    s_add_u32 s9, s9, 8192
    buffer_load_dwordx4 v253, s[92:95], s9 offen lds
    s_add_u32 m0, s97, 24576
    s_add_u32 s9, s96, 196608
    buffer_load_dwordx4 v253, s[92:95], s9 offen lds
    s_add_u32 m0, s97, 25600
    s_add_u32 s9, s9, 8192
    buffer_load_dwordx4 v253, s[92:95], s9 offen lds
    s_mov_b32 s14, 1
    s_call_b64 s[100:101], L_setup
    s_nop 0
    s_waitcnt vmcnt(4)
    v_mov_b32 v22, s99
    v_mov_b32 v23, 1
    s_mov_b64 exec, 1
    global_store_dword v22, v23, s[34:35] sc1
    s_mov_b64 exec, -1
    s_barrier
    s_add_u32 m0, s97, 8192
    s_add_u32 s9, s96, 65536
    buffer_load_dwordx4 v253, s[92:95], s9 offen lds
    s_add_u32 m0, s97, 9216
    s_add_u32 s9, s9, 8192
    buffer_load_dwordx4 v253, s[92:95], s9 offen lds
    s_add_u32 m0, s97, 32768
    s_add_u32 s9, s96, 128
    buffer_load_dwordx4 v253, s[92:95], s9 offen lds
    s_add_u32 m0, s97, 33792
    s_add_u32 s9, s9, 8192
    buffer_load_dwordx4 v253, s[92:95], s9 offen lds
    s_add_u32 m0, s97, 40960
    s_add_u32 s9, s96, 65664
    buffer_load_dwordx4 v253, s[92:95], s9 offen lds
    s_add_u32 m0, s97, 41984
    s_add_u32 s9, s9, 8192
    buffer_load_dwordx4 v253, s[92:95], s9 offen lds
    s_add_u32 m0, s97, 49152
    s_add_u32 s9, s96, 131200
    buffer_load_dwordx4 v253, s[92:95], s9 offen lds
    s_add_u32 m0, s97, 50176
    s_add_u32 s9, s9, 8192
    buffer_load_dwordx4 v253, s[92:95], s9 offen lds
    s_add_u32 m0, s97, 57344
    s_add_u32 s9, s96, 196736
    buffer_load_dwordx4 v253, s[92:95], s9 offen lds
    s_add_u32 m0, s97, 58368
    s_add_u32 s9, s9, 8192
    buffer_load_dwordx4 v253, s[92:95], s9 offen lds
    s_add_u32 m0, s97, 65536
    s_add_u32 s9, s96, 262144
    buffer_load_dwordx4 v253, s[92:95], s9 offen lds
    s_add_u32 m0, s97, 66560
    s_add_u32 s9, s9, 8192
    buffer_load_dwordx4 v253, s[92:95], s9 offen lds
    s_add_u32 m0, s97, 73728
    s_add_u32 s9, s96, 327680
    buffer_load_dwordx4 v253, s[92:95], s9 offen lds
    s_add_u32 m0, s97, 74752
    s_add_u32 s9, s9, 8192
    buffer_load_dwordx4 v253, s[92:95], s9 offen lds
    s_add_u32 m0, s97, 81920
    s_add_u32 s9, s96, 393216
    buffer_load_dwordx4 v253, s[92:95], s9 offen lds
    s_add_u32 m0, s97, 82944
    s_add_u32 s9, s9, 8192
    buffer_load_dwordx4 v253, s[92:95], s9 offen lds
    s_branch L_p2w
L_zero:
    s_lshl_b32 s9, s47, 2
    s_add_u32 s9, s9, s11
    s_mul_i32 s9, s9, 3840
    s_add_u32 s9, s9, 4259840
    v_lshlrev_b32 v20, 4, v1
    v_add_u32 v20, s9, v20
    v_mov_b32 v24, 0
    v_mov_b32 v25, 0
    v_mov_b32 v26, 0
    v_mov_b32 v27, 0
    global_store_dwordx4 v20, v[24:27], s[34:35] sc0 sc1
    global_store_dwordx4 v20, v[24:27], s[34:35] offset:1024 sc0 sc1
    global_store_dwordx4 v20, v[24:27], s[34:35] offset:2048 sc0 sc1
    global_store_dwordx4 v20, v[24:27], s[34:35] offset:2816 sc0 sc1
    s_branch L_zero_back
L_ssm:
    s_nop 4
    s_and_b32 s63, s46, 3
    s_lshr_b32 s62, s46, 2
    s_lshl_b32 s62, s62, 1
    s_bfe_u32 s9, s2, 65543
    s_add_u32 s62, s62, s9
    s_lshl_b32 s9, s45, 3
    s_add_u32 s62, s62, s9
    v_lshrrev_b32 v255, 2, v1
    v_and_b32 v255, 4, v255
    v_and_b32 v253, 7, v1
    v_xor_b32 v255, v255, v253
    v_lshlrev_b32 v255, 4, v255
    v_lshl_add_u32 v253, v254, 10, v255
    v_lshrrev_b32 v255, 5, v1
    v_bfe_u32 v237, v1, 2, 2
    v_lshl_add_u32 v238, v255, 2, v237
    v_lshlrev_b32 v238, 7, v238
    v_lshrrev_b32 v237, 1, v237
    s_and_b32 s9, s11, 1
    v_xor_b32 v237, s9, v237
    v_lshl_add_u32 v238, v237, 6, v238
    v_bfe_u32 v237, v1, 4, 1
    v_lshl_add_u32 v238, v237, 5, v238
    v_and_b32 v237, 3, v1
    v_lshl_add_u32 v238, v237, 3, v238
    s_lshr_b32 s9, s11, 1
    s_lshl_b32 s9, s9, 15
    v_add_u32 v238, s9, v238
    s_mov_b32 s14, 0
    s_lshl_b32 s96, s11, 14
    s_lshl_b32 s9, s63, 8
    s_add_u32 s96, s96, s9
    s_mov_b32 s92, s12
    s_and_b32 s93, s13, 0xffff
    s_mov_b32 s94, 524288
    s_mov_b32 s95, 0x00020000
    s_mul_i32 s50, s11, 2752
    s_add_u32 s50, s50, 99072
    s_lshl_b32 s51, s11, 9
    v_mul_u32_u24 v14, 1280, v251
    v_lshl_add_u32 v14, v250, 4, v14
    v_lshl_add_u32 v14, v12, 3, v14
    v_add_u32 v248, 143616, v14
    s_lshl_b32 s9, s49, 8
    s_add_u32 s98, s9, s51
    s_add_u32 s99, s98, 59856
    s_lshl_b32 s9, s47, 2
    s_add_u32 s9, s9, s11
    s_lshl_b32 s48, s9, 12
    s_waitcnt lgkmcnt(0)
    s_cmp_ge_u32 s11, 2
    s_cselect_b32 s9, s53, s52
    s_cselect_b32 s60, s55, s54
    s_lshl_b32 s10, s9, 16
    s_and_b32 s9, s9, 0xffff0000
    s_lshl_b32 s61, s60, 16
    s_and_b32 s60, s60, 0xffff0000
    s_bitcmp1_b32 s11, 0
    s_cselect_b32 s9, s9, s10
    s_cselect_b32 s60, s60, s61
    s_mov_b32 s56, 0x3fb8aa00
    s_mov_b32 s57, 0x36eca570
    v_mov_b32 v8, s9
    v_mul_f32 v10, s56, v8
    v_rndne_f32 v11, v10
    v_sub_f32 v10, v10, v11
    v_fma_f32 v10, v8, s57, v10
    v_exp_f32 v10, v10
    v_cvt_i32_f32 v11, v11
    v_ldexp_f32 v10, v10, v11
    v_cvt_pk_bf16_f32 v10, v10, v10
    v_lshlrev_b32 v8, 16, v10
    s_mov_b32 m0, s98
    v_mov_b32 v10, 0x3f80
    ds_write_addtid_b32 v10
    s_waitcnt vmcnt(2)
    s_cmp_ge_u32 s15, 8
    s_cbranch_scc1 Lf_9
    s_lshl_b32 s9, s47, 2
    s_add_u32 s9, s9, s11
    v_mov_b32 v20, s9
    v_mov_b32 v21, 1
    s_mov_b64 exec, 1
    global_store_byte v20, v21, s[32:33] sc0 sc1
    s_mov_b64 exec, -1
Lf_9:
    v_lshlrev_b32 v4, 16, v4
    v_lshlrev_b32 v5, 16, v5
    v_lshlrev_b32 v6, 16, v6
    v_lshlrev_b32 v7, 16, v7
    v_mul_f32 v10, s56, v4
    v_rndne_f32 v11, v10
    v_sub_f32 v10, v10, v11
    v_fma_f32 v10, v4, s57, v10
    v_exp_f32 v10, v10
    v_cvt_i32_f32 v11, v11
    v_ldexp_f32 v10, v10, v11
    v_cvt_pk_bf16_f32 v10, v10, v10
    v_lshlrev_b32 v4, 16, v10
    v_mul_f32 v4, v4, v8
    v_mul_f32 v4, 0xbfb8aa3b, v4
    v_mul_f32 v5, v5, v8
    v_mul_f32 v5, 0.15915494, v5
    v_add_f32 v9, v8, v8
    v_mul_f32 v30, v6, v9
    v_mul_f32_e64 v31, v7, -v9
    v_mul_f32 v10, 0x41000000, v4
    v_mul_f32 v11, 0x41000000, v5
    v_exp_f32 v10, v10
    v_fract_f32 v11, v11
    v_exp_f32 v12, v4
    v_fract_f32 v13, v5
    v_mul_f32 v14, 0x43800000, v4
    v_mul_f32 v15, 0x43800000, v5
    v_exp_f32 v14, v14
    v_fract_f32 v15, v15
    v_mul_f32 v16, 0x44000000, v4
    v_mul_f32 v17, 0x44000000, v5
    v_exp_f32 v16, v16
    v_fract_f32 v17, v17
    v_mul_f32 v18, 0x44800000, v4
    v_mul_f32 v19, 0x44800000, v5
    v_exp_f32 v18, v18
    v_fract_f32 v19, v19
    v_cos_f32 v66, v11
    v_sin_f32 v67, v11
    v_cos_f32 v20, v13
    v_sin_f32 v21, v13
    v_cos_f32 v24, v15
    v_sin_f32 v25, v15
    v_cos_f32 v26, v17
    v_sin_f32 v27, v17
    v_cos_f32 v28, v19
    v_sin_f32 v29, v19
    v_mul_f32 v66, v66, v10
    v_mul_f32 v67, v67, v10
    v_mul_f32 v20, v20, v12
    v_mul_f32 v21, v21, v12
    v_mul_f32 v24, v24, v14
    v_mul_f32 v25, v25, v14
    v_mul_f32 v26, v26, v16
    v_mul_f32 v27, v27, v16
    v_mul_f32 v28, v28, v18
    v_mul_f32 v29, v29, v18
    v_cvt_pk_bf16_f32 v10, v66, v67
    v_cvt_pk_bf16_f32 v11, v30, v31
    ds_write_addtid_b32 v10 offset:2064
    s_mov_b32 m0, s99
    s_nop 0
    ds_write_addtid_b32 v11 offset:6192
    v_pk_mul_f32 v[68:69], v[66:67], v[66:67] op_sel:[0,0] op_sel_hi:[1,0]
    v_pk_mul_f32 v[32:33], v[30:31], v[20:21] op_sel:[0,0] op_sel_hi:[1,0]
    v_pk_mul_f32 v[128:129], v[30:31], v[24:25] op_sel:[0,0] op_sel_hi:[1,0]
    v_pk_mul_f32 v[130:131], v[30:31], v[26:27] op_sel:[0,0] op_sel_hi:[1,0]
    v_pk_fma_f32 v[68:69], v[66:67], v[66:67], v[68:69] op_sel:[1,1,0] op_sel_hi:[0,1,1] neg_lo:[1,0,0]
    v_pk_fma_f32 v[32:33], v[30:31], v[20:21], v[32:33] op_sel:[1,1,0] op_sel_hi:[0,1,1] neg_hi:[1,0,0]
    v_pk_fma_f32 v[128:129], v[30:31], v[24:25], v[128:129] op_sel:[1,1,0] op_sel_hi:[0,1,1] neg_hi:[1,0,0]
    v_pk_fma_f32 v[130:131], v[30:31], v[26:27], v[130:131] op_sel:[1,1,0] op_sel_hi:[0,1,1] neg_hi:[1,0,0]
    v_cvt_pk_bf16_f32 v12, v68, v69
    v_cvt_pk_bf16_f32 v13, v32, v33
    v_cvt_pk_bf16_f32 v14, v128, v129
    v_cvt_pk_bf16_f32 v15, v130, v131
    ds_write_addtid_b32 v13 offset:8256
    ds_write_addtid_b32 v14 offset:14448
    ds_write_addtid_b32 v14 offset:16512
    ds_write_addtid_b32 v15 offset:39216
    s_mov_b32 m0, s98
    s_nop 0
    ds_write_addtid_b32 v12 offset:4128
    v_pk_mul_f32 v[70:71], v[68:69], v[66:67] op_sel:[0,0] op_sel_hi:[1,0]
    v_pk_mul_f32 v[72:73], v[68:69], v[68:69] op_sel:[0,0] op_sel_hi:[1,0]
    v_pk_mul_f32 v[34:35], v[32:33], v[20:21] op_sel:[0,0] op_sel_hi:[1,0]
    v_pk_mul_f32 v[132:133], v[128:129], v[26:27] op_sel:[0,0] op_sel_hi:[1,0]
    v_pk_fma_f32 v[70:71], v[68:69], v[66:67], v[70:71] op_sel:[1,1,0] op_sel_hi:[0,1,1] neg_lo:[1,0,0]
    v_pk_fma_f32 v[72:73], v[68:69], v[68:69], v[72:73] op_sel:[1,1,0] op_sel_hi:[0,1,1] neg_lo:[1,0,0]
    v_pk_fma_f32 v[34:35], v[32:33], v[20:21], v[34:35] op_sel:[1,1,0] op_sel_hi:[0,1,1] neg_hi:[1,0,0]
    v_pk_fma_f32 v[132:133], v[128:129], v[26:27], v[132:133] op_sel:[1,1,0] op_sel_hi:[0,1,1] neg_hi:[1,0,0]
    v_cvt_pk_bf16_f32 v16, v70, v71
    v_cvt_pk_bf16_f32 v17, v72, v73
    v_cvt_pk_bf16_f32 v18, v34, v35
    v_cvt_pk_bf16_f32 v19, v132, v133
    ds_write_addtid_b32 v16 offset:6192
    ds_write_addtid_b32 v17 offset:8256
    s_mov_b32 m0, s99
    s_nop 0
    ds_write_addtid_b32 v18 offset:10320
    ds_write_addtid_b32 v19 offset:47472
    v_pk_mul_f32 v[74:75], v[66:67], v[72:73] op_sel:[0,0] op_sel_hi:[1,0]
    v_pk_mul_f32 v[76:77], v[68:69], v[72:73] op_sel:[0,0] op_sel_hi:[1,0]
    v_pk_mul_f32 v[78:79], v[70:71], v[72:73] op_sel:[0,0] op_sel_hi:[1,0]
    v_pk_mul_f32 v[80:81], v[72:73], v[72:73] op_sel:[0,0] op_sel_hi:[1,0]
    v_pk_mul_f32 v[36:37], v[34:35], v[20:21] op_sel:[0,0] op_sel_hi:[1,0]
    v_pk_mul_f32 v[134:135], v[34:35], v[24:25] op_sel:[0,0] op_sel_hi:[1,0]
    v_pk_fma_f32 v[74:75], v[66:67], v[72:73], v[74:75] op_sel:[1,1,0] op_sel_hi:[0,1,1] neg_lo:[1,0,0]
    v_pk_fma_f32 v[76:77], v[68:69], v[72:73], v[76:77] op_sel:[1,1,0] op_sel_hi:[0,1,1] neg_lo:[1,0,0]
    v_pk_fma_f32 v[78:79], v[70:71], v[72:73], v[78:79] op_sel:[1,1,0] op_sel_hi:[0,1,1] neg_lo:[1,0,0]
    v_pk_fma_f32 v[80:81], v[72:73], v[72:73], v[80:81] op_sel:[1,1,0] op_sel_hi:[0,1,1] neg_lo:[1,0,0]
    v_pk_fma_f32 v[36:37], v[34:35], v[20:21], v[36:37] op_sel:[1,1,0] op_sel_hi:[0,1,1] neg_hi:[1,0,0]
    v_pk_fma_f32 v[134:135], v[34:35], v[24:25], v[134:135] op_sel:[1,1,0] op_sel_hi:[0,1,1] neg_hi:[1,0,0]
    v_cvt_pk_bf16_f32 v10, v74, v75
    v_cvt_pk_bf16_f32 v11, v76, v77
    v_cvt_pk_bf16_f32 v12, v78, v79
    v_cvt_pk_bf16_f32 v13, v80, v81
    v_cvt_pk_bf16_f32 v14, v36, v37
    v_cvt_pk_bf16_f32 v15, v134, v135
    ds_write_addtid_b32 v14 offset:12384
    ds_write_addtid_b32 v15 offset:18576
    s_mov_b32 m0, s98
    s_nop 0
    ds_write_addtid_b32 v10 offset:10320
    ds_write_addtid_b32 v11 offset:12384
    ds_write_addtid_b32 v12 offset:14448
    ds_write_addtid_b32 v13 offset:16512
    v_pk_mul_f32 v[82:83], v[74:75], v[72:73] op_sel:[0,0] op_sel_hi:[1,0]
    v_pk_mul_f32 v[84:85], v[76:77], v[72:73] op_sel:[0,0] op_sel_hi:[1,0]
    v_pk_mul_f32 v[86:87], v[78:79], v[72:73] op_sel:[0,0] op_sel_hi:[1,0]
    v_pk_mul_f32 v[88:89], v[80:81], v[72:73] op_sel:[0,0] op_sel_hi:[1,0]
    v_pk_mul_f32 v[38:39], v[36:37], v[20:21] op_sel:[0,0] op_sel_hi:[1,0]
    v_pk_fma_f32 v[82:83], v[74:75], v[72:73], v[82:83] op_sel:[1,1,0] op_sel_hi:[0,1,1] neg_lo:[1,0,0]
    v_pk_fma_f32 v[84:85], v[76:77], v[72:73], v[84:85] op_sel:[1,1,0] op_sel_hi:[0,1,1] neg_lo:[1,0,0]
    v_pk_fma_f32 v[86:87], v[78:79], v[72:73], v[86:87] op_sel:[1,1,0] op_sel_hi:[0,1,1] neg_lo:[1,0,0]
    v_pk_fma_f32 v[88:89], v[80:81], v[72:73], v[88:89] op_sel:[1,1,0] op_sel_hi:[0,1,1] neg_lo:[1,0,0]
    v_pk_fma_f32 v[38:39], v[36:37], v[20:21], v[38:39] op_sel:[1,1,0] op_sel_hi:[0,1,1] neg_hi:[1,0,0]
    v_cvt_pk_bf16_f32 v16, v82, v83
    v_cvt_pk_bf16_f32 v17, v84, v85
    v_cvt_pk_bf16_f32 v18, v86, v87
    v_cvt_pk_bf16_f32 v19, v88, v89
    v_cvt_pk_bf16_f32 v10, v38, v39
    ds_write_addtid_b32 v16 offset:18576
    ds_write_addtid_b32 v17 offset:20640
    ds_write_addtid_b32 v18 offset:22704
    ds_write_addtid_b32 v19 offset:24768
    s_mov_b32 m0, s99
    s_nop 0
    ds_write_addtid_b32 v10 offset:22704
    global_load_dwordx2 v[244:245], v249, s[4:5] offset:2048
    v_pk_mul_f32 v[90:91], v[82:83], v[72:73] op_sel:[0,0] op_sel_hi:[1,0]
    v_pk_mul_f32 v[92:93], v[84:85], v[72:73] op_sel:[0,0] op_sel_hi:[1,0]
    v_pk_mul_f32 v[94:95], v[86:87], v[72:73] op_sel:[0,0] op_sel_hi:[1,0]
    v_pk_mul_f32 v[96:97], v[88:89], v[72:73] op_sel:[0,0] op_sel_hi:[1,0]
    v_pk_mul_f32 v[40:41], v[38:39], v[20:21] op_sel:[0,0] op_sel_hi:[1,0]
    v_pk_mul_f32 v[136:137], v[38:39], v[24:25] op_sel:[0,0] op_sel_hi:[1,0]
    v_pk_mul_f32 v[138:139], v[38:39], v[26:27] op_sel:[0,0] op_sel_hi:[1,0]
    v_pk_fma_f32 v[90:91], v[82:83], v[72:73], v[90:91] op_sel:[1,1,0] op_sel_hi:[0,1,1] neg_lo:[1,0,0]
    v_pk_fma_f32 v[92:93], v[84:85], v[72:73], v[92:93] op_sel:[1,1,0] op_sel_hi:[0,1,1] neg_lo:[1,0,0]
    v_pk_fma_f32 v[94:95], v[86:87], v[72:73], v[94:95] op_sel:[1,1,0] op_sel_hi:[0,1,1] neg_lo:[1,0,0]
    v_pk_fma_f32 v[96:97], v[88:89], v[72:73], v[96:97] op_sel:[1,1,0] op_sel_hi:[0,1,1] neg_lo:[1,0,0]
    v_pk_fma_f32 v[40:41], v[38:39], v[20:21], v[40:41] op_sel:[1,1,0] op_sel_hi:[0,1,1] neg_hi:[1,0,0]
    v_pk_fma_f32 v[136:137], v[38:39], v[24:25], v[136:137] op_sel:[1,1,0] op_sel_hi:[0,1,1] neg_hi:[1,0,0]
    v_pk_fma_f32 v[138:139], v[38:39], v[26:27], v[138:139] op_sel:[1,1,0] op_sel_hi:[0,1,1] neg_hi:[1,0,0]
    v_cvt_pk_bf16_f32 v11, v90, v91
    v_cvt_pk_bf16_f32 v12, v92, v93
    v_cvt_pk_bf16_f32 v13, v94, v95
    v_cvt_pk_bf16_f32 v14, v96, v97
    v_cvt_pk_bf16_f32 v15, v40, v41
    v_cvt_pk_bf16_f32 v16, v136, v137
    v_cvt_pk_bf16_f32 v17, v138, v139
    ds_write_addtid_b32 v15 offset:24768
    ds_write_addtid_b32 v16 offset:20640
    ds_write_addtid_b32 v16 offset:30960
    ds_write_addtid_b32 v16 offset:33024
    ds_write_addtid_b32 v17 offset:41280
    s_mov_b32 m0, s98
    s_nop 0
    ds_write_addtid_b32 v11 offset:26832
    ds_write_addtid_b32 v12 offset:28896
    ds_write_addtid_b32 v13 offset:30960
    ds_write_addtid_b32 v14 offset:33024
    v_pk_mul_f32 v[98:99], v[90:91], v[72:73] op_sel:[0,0] op_sel_hi:[1,0]
    v_pk_mul_f32 v[100:101], v[92:93], v[72:73] op_sel:[0,0] op_sel_hi:[1,0]
    v_pk_mul_f32 v[102:103], v[94:95], v[72:73] op_sel:[0,0] op_sel_hi:[1,0]
    v_pk_mul_f32 v[104:105], v[96:97], v[72:73] op_sel:[0,0] op_sel_hi:[1,0]
    v_pk_mul_f32 v[42:43], v[40:41], v[20:21] op_sel:[0,0] op_sel_hi:[1,0]
    v_pk_mul_f32 v[140:141], v[136:137], v[26:27] op_sel:[0,0] op_sel_hi:[1,0]
    v_pk_fma_f32 v[98:99], v[90:91], v[72:73], v[98:99] op_sel:[1,1,0] op_sel_hi:[0,1,1] neg_lo:[1,0,0]
    v_pk_fma_f32 v[100:101], v[92:93], v[72:73], v[100:101] op_sel:[1,1,0] op_sel_hi:[0,1,1] neg_lo:[1,0,0]
    v_pk_fma_f32 v[102:103], v[94:95], v[72:73], v[102:103] op_sel:[1,1,0] op_sel_hi:[0,1,1] neg_lo:[1,0,0]
    v_pk_fma_f32 v[104:105], v[96:97], v[72:73], v[104:105] op_sel:[1,1,0] op_sel_hi:[0,1,1] neg_lo:[1,0,0]
    v_pk_fma_f32 v[42:43], v[40:41], v[20:21], v[42:43] op_sel:[1,1,0] op_sel_hi:[0,1,1] neg_hi:[1,0,0]
    v_pk_fma_f32 v[140:141], v[136:137], v[26:27], v[140:141] op_sel:[1,1,0] op_sel_hi:[0,1,1] neg_hi:[1,0,0]
    v_cvt_pk_bf16_f32 v18, v98, v99
    v_cvt_pk_bf16_f32 v19, v100, v101
    v_cvt_pk_bf16_f32 v10, v102, v103
    v_cvt_pk_bf16_f32 v11, v104, v105
    v_cvt_pk_bf16_f32 v12, v42, v43
    v_cvt_pk_bf16_f32 v13, v140, v141
    ds_write_addtid_b32 v18 offset:35088
    ds_write_addtid_b32 v19 offset:37152
    ds_write_addtid_b32 v10 offset:39216
    ds_write_addtid_b32 v11 offset:41280
    s_mov_b32 m0, s99
    s_nop 0
    ds_write_addtid_b32 v12 offset:26832
    ds_write_addtid_b32 v13 offset:49536
    v_pk_mul_f32 v[106:107], v[98:99], v[72:73] op_sel:[0,0] op_sel_hi:[1,0]
    v_pk_mul_f32 v[108:109], v[100:101], v[72:73] op_sel:[0,0] op_sel_hi:[1,0]
    v_pk_mul_f32 v[110:111], v[102:103], v[72:73] op_sel:[0,0] op_sel_hi:[1,0]
    v_pk_mul_f32 v[112:113], v[104:105], v[72:73] op_sel:[0,0] op_sel_hi:[1,0]
    v_pk_mul_f32 v[44:45], v[42:43], v[20:21] op_sel:[0,0] op_sel_hi:[1,0]
    v_pk_mul_f32 v[142:143], v[42:43], v[24:25] op_sel:[0,0] op_sel_hi:[1,0]
    v_pk_fma_f32 v[106:107], v[98:99], v[72:73], v[106:107] op_sel:[1,1,0] op_sel_hi:[0,1,1] neg_lo:[1,0,0]
    v_pk_fma_f32 v[108:109], v[100:101], v[72:73], v[108:109] op_sel:[1,1,0] op_sel_hi:[0,1,1] neg_lo:[1,0,0]
    v_pk_fma_f32 v[110:111], v[102:103], v[72:73], v[110:111] op_sel:[1,1,0] op_sel_hi:[0,1,1] neg_lo:[1,0,0]
    v_pk_fma_f32 v[112:113], v[104:105], v[72:73], v[112:113] op_sel:[1,1,0] op_sel_hi:[0,1,1] neg_lo:[1,0,0]
    v_pk_fma_f32 v[44:45], v[42:43], v[20:21], v[44:45] op_sel:[1,1,0] op_sel_hi:[0,1,1] neg_hi:[1,0,0]
    v_pk_fma_f32 v[142:143], v[42:43], v[24:25], v[142:143] op_sel:[1,1,0] op_sel_hi:[0,1,1] neg_hi:[1,0,0]
    v_cvt_pk_bf16_f32 v14, v106, v107
    v_cvt_pk_bf16_f32 v15, v108, v109
    v_cvt_pk_bf16_f32 v16, v110, v111
    v_cvt_pk_bf16_f32 v17, v112, v113
    v_cvt_pk_bf16_f32 v18, v44, v45
    v_cvt_pk_bf16_f32 v19, v142, v143
    ds_write_addtid_b32 v18 offset:28896
    ds_write_addtid_b32 v19 offset:35088
    s_mov_b32 m0, s98
    s_nop 0
    ds_write_addtid_b32 v14 offset:43344
    ds_write_addtid_b32 v15 offset:45408
    ds_write_addtid_b32 v16 offset:47472
    ds_write_addtid_b32 v17 offset:49536
    global_load_dwordx2 v[246:247], v249, s[4:5] offset:3072
    v_pk_mul_f32 v[114:115], v[106:107], v[72:73] op_sel:[0,0] op_sel_hi:[1,0]
    v_pk_mul_f32 v[116:117], v[108:109], v[72:73] op_sel:[0,0] op_sel_hi:[1,0]
    v_pk_mul_f32 v[118:119], v[110:111], v[72:73] op_sel:[0,0] op_sel_hi:[1,0]
    v_pk_mul_f32 v[120:121], v[112:113], v[72:73] op_sel:[0,0] op_sel_hi:[1,0]
    v_pk_mul_f32 v[46:47], v[44:45], v[20:21] op_sel:[0,0] op_sel_hi:[1,0]
    v_pk_fma_f32 v[114:115], v[106:107], v[72:73], v[114:115] op_sel:[1,1,0] op_sel_hi:[0,1,1] neg_lo:[1,0,0]
    v_pk_fma_f32 v[116:117], v[108:109], v[72:73], v[116:117] op_sel:[1,1,0] op_sel_hi:[0,1,1] neg_lo:[1,0,0]
    v_pk_fma_f32 v[118:119], v[110:111], v[72:73], v[118:119] op_sel:[1,1,0] op_sel_hi:[0,1,1] neg_lo:[1,0,0]
    v_pk_fma_f32 v[120:121], v[112:113], v[72:73], v[120:121] op_sel:[1,1,0] op_sel_hi:[0,1,1] neg_lo:[1,0,0]
    v_pk_fma_f32 v[46:47], v[44:45], v[20:21], v[46:47] op_sel:[1,1,0] op_sel_hi:[0,1,1] neg_hi:[1,0,0]
    v_cvt_pk_bf16_f32 v10, v114, v115
    v_cvt_pk_bf16_f32 v11, v116, v117
    v_cvt_pk_bf16_f32 v12, v118, v119
    v_cvt_pk_bf16_f32 v13, v120, v121
    ds_write_addtid_b32 v10 offset:51600
    ds_write_addtid_b32 v11 offset:53664
    ds_write_addtid_b32 v12 offset:55728
    ds_write_addtid_b32 v13 offset:57792
    v_pk_mul_f32 v[122:123], v[114:115], v[72:73] op_sel:[0,0] op_sel_hi:[1,0]
    v_pk_mul_f32 v[124:125], v[116:117], v[72:73] op_sel:[0,0] op_sel_hi:[1,0]
    v_pk_mul_f32 v[126:127], v[118:119], v[72:73] op_sel:[0,0] op_sel_hi:[1,0]
    v_pk_mul_f32 v[144:145], v[46:47], v[24:25] op_sel:[0,0] op_sel_hi:[1,0]
    v_pk_mul_f32 v[146:147], v[46:47], v[26:27] op_sel:[0,0] op_sel_hi:[1,0]
    v_pk_mul_f32 v[148:149], v[46:47], v[28:29] op_sel:[0,0] op_sel_hi:[1,0]
    v_pk_fma_f32 v[122:123], v[114:115], v[72:73], v[122:123] op_sel:[1,1,0] op_sel_hi:[0,1,1] neg_lo:[1,0,0]
    v_pk_fma_f32 v[124:125], v[116:117], v[72:73], v[124:125] op_sel:[1,1,0] op_sel_hi:[0,1,1] neg_lo:[1,0,0]
    v_pk_fma_f32 v[126:127], v[118:119], v[72:73], v[126:127] op_sel:[1,1,0] op_sel_hi:[0,1,1] neg_lo:[1,0,0]
    v_pk_fma_f32 v[144:145], v[46:47], v[24:25], v[144:145] op_sel:[1,1,0] op_sel_hi:[0,1,1] neg_hi:[1,0,0]
    v_pk_fma_f32 v[146:147], v[46:47], v[26:27], v[146:147] op_sel:[1,1,0] op_sel_hi:[0,1,1] neg_hi:[1,0,0]
    v_pk_fma_f32 v[148:149], v[46:47], v[28:29], v[148:149] op_sel:[1,1,0] op_sel_hi:[0,1,1] neg_hi:[1,0,0]
    v_cvt_pk_bf16_f32 v14, v122, v123
    v_cvt_pk_bf16_f32 v15, v124, v125
    v_cvt_pk_bf16_f32 v16, v126, v127
    v_cvt_pk_bf16_f32 v17, v144, v145
    v_cvt_pk_bf16_f32 v18, v146, v147
    v_cvt_pk_bf16_f32 v19, v148, v149
    s_mov_b32 m0, s99
    s_nop 0
    ds_write_addtid_b32 v14 offset:0
    ds_write_addtid_b32 v15 offset:2064
    ds_write_addtid_b32 v16 offset:4128
    ds_write_addtid_b32 v17 offset:37152
    ds_write_addtid_b32 v18 offset:43344
    ds_write_addtid_b32 v19 offset:45408
    v_pk_mul_f32 v[150:151], v[144:145], v[26:27] op_sel:[0,0] op_sel_hi:[1,0]
    v_pk_mul_f32 v[152:153], v[144:145], v[28:29] op_sel:[0,0] op_sel_hi:[1,0]
    v_pk_mul_f32 v[154:155], v[146:147], v[28:29] op_sel:[0,0] op_sel_hi:[1,0]
    v_pk_fma_f32 v[150:151], v[144:145], v[26:27], v[150:151] op_sel:[1,1,0] op_sel_hi:[0,1,1] neg_hi:[1,0,0]
    v_pk_fma_f32 v[152:153], v[144:145], v[28:29], v[152:153] op_sel:[1,1,0] op_sel_hi:[0,1,1] neg_hi:[1,0,0]
    v_pk_fma_f32 v[154:155], v[146:147], v[28:29], v[154:155] op_sel:[1,1,0] op_sel_hi:[0,1,1] neg_hi:[1,0,0]
    v_cvt_pk_bf16_f32 v10, v150, v151
    v_cvt_pk_bf16_f32 v11, v152, v153
    v_cvt_pk_bf16_f32 v12, v154, v155
    ds_write_addtid_b32 v10 offset:51600
    ds_write_addtid_b32 v11 offset:55728
    ds_write_addtid_b32 v12 offset:53664
    v_pk_mul_f32 v[156:157], v[150:151], v[28:29] op_sel:[0,0] op_sel_hi:[1,0]
    v_pk_fma_f32 v[156:157], v[150:151], v[28:29], v[156:157] op_sel:[1,1,0] op_sel_hi:[0,1,1] neg_hi:[1,0,0]
    v_cvt_pk_bf16_f32 v13, v156, v157
    ds_write_addtid_b32 v13 offset:57792
    v_lshlrev_b32 v6, 4, v1
    v_add_u32 v6, s50, v6
    s_cmp_lg_u32 s49, 0
    s_cbranch_scc1 L_s_h1
    v_and_b32 v10, 31, v1
    v_min_u32 v11, 25, v10
    v_add_u32 v11, 32, v11
    v_mul_u32_u24 v10, 2064, v10
    v_mul_u32_u24 v11, 2064, v11
    v_lshrrev_b32 v12, 5, v1
    v_lshlrev_b32 v12, 4, v12
    v_add_u32 v12, s51, v12
    v_add_u32 v4, v10, v12
    v_add_u32 v5, v11, v12
    v_lshlrev_b32 v10, 4, v1
    s_add_u32 s9, s50, 34352
    v_sub_u32 v10, s9, v10
    v_and_b32 v11, 3, v1
    v_lshlrev_b32 v11, 7, v11
    v_bfe_u32 v12, v1, 2, 3
    v_lshlrev_b32 v12, 1, v12
    v_sub_u32 v11, v11, v12
    v_lshrrev_b32 v12, 5, v1
    v_lshlrev_b32 v12, 5, v12
    v_sub_u32 v11, v11, v12
    s_add_u32 s9, s50, 35456
    v_add_u32 v11, s9, v11
    v_mov_b32 v13, s60
    v_cmp_eq_u32 vcc, 0, v1
    s_nop 1
    v_cndmask_b32 v13, 0, v13, vcc
    v_mov_b32 v12, s50
    s_waitcnt lgkmcnt(0)
    s_barrier
    ds_read_b128 v[64:67], v5 offset:0
    ds_read_b128 v[68:71], v4 offset:0
    ds_read_b128 v[72:75], v5 offset:32
    ds_read_b128 v[76:79], v4 offset:32
    ds_read_b128 v[80:83], v5 offset:64
    ds_read_b128 v[84:87], v4 offset:64
    ds_read_b128 v[88:91], v5 offset:96
    ds_read_b128 v[92:95], v4 offset:96
    ds_read_b128 v[96:99], v5 offset:128
    ds_read_b128 v[100:103], v4 offset:128
    ds_read_b128 v[104:107], v5 offset:160
    ds_read_b128 v[108:111], v4 offset:160
    ds_read_b128 v[112:115], v5 offset:192
    ds_read_b128 v[116:119], v4 offset:192
    ds_read_b128 v[120:123], v5 offset:224
    ds_read_b128 v[124:127], v4 offset:224
    s_waitcnt lgkmcnt(14)
    v_mfma_f32_32x32x16_bf16 v[32:47], v[64:67], v[68:71], 0
    ds_read_b128 v[64:67], v5 offset:256
    ds_read_b128 v[68:71], v4 offset:256
    s_waitcnt lgkmcnt(14)
    v_mfma_f32_32x32x16_bf16 v[32:47], v[72:75], v[76:79], v[32:47]
    ds_read_b128 v[72:75], v5 offset:288
    ds_read_b128 v[76:79], v4 offset:288
    s_waitcnt lgkmcnt(14)
    v_mfma_f32_32x32x16_bf16 v[32:47], v[80:83], v[84:87], v[32:47]
    ds_read_b128 v[80:83], v5 offset:320
    ds_read_b128 v[84:87], v4 offset:320
    s_waitcnt lgkmcnt(14)
    v_mfma_f32_32x32x16_bf16 v[32:47], v[88:91], v[92:95], v[32:47]
    ds_read_b128 v[88:91], v5 offset:352
    ds_read_b128 v[92:95], v4 offset:352
    s_waitcnt lgkmcnt(14)
    v_mfma_f32_32x32x16_bf16 v[32:47], v[96:99], v[100:103], v[32:47]
    ds_read_b128 v[96:99], v5 offset:384
    ds_read_b128 v[100:103], v4 offset:384
    s_waitcnt lgkmcnt(14)
    v_mfma_f32_32x32x16_bf16 v[32:47], v[104:107], v[108:111], v[32:47]
    ds_read_b128 v[104:107], v5 offset:416
    ds_read_b128 v[108:111], v4 offset:416
    s_waitcnt lgkmcnt(14)
    v_mfma_f32_32x32x16_bf16 v[32:47], v[112:115], v[116:119], v[32:47]
    ds_read_b128 v[112:115], v5 offset:448
    ds_read_b128 v[116:119], v4 offset:448
    s_waitcnt lgkmcnt(14)
    v_mfma_f32_32x32x16_bf16 v[32:47], v[120:123], v[124:127], v[32:47]
    ds_read_b128 v[120:123], v5 offset:480
    ds_read_b128 v[124:127], v4 offset:480
    s_waitcnt lgkmcnt(14)
    v_mfma_f32_32x32x16_bf16 v[32:47], v[64:67], v[68:71], v[32:47]
    s_waitcnt lgkmcnt(12)
    v_mfma_f32_32x32x16_bf16 v[32:47], v[72:75], v[76:79], v[32:47]
    s_waitcnt lgkmcnt(10)
    v_mfma_f32_32x32x16_bf16 v[32:47], v[80:83], v[84:87], v[32:47]
    s_waitcnt lgkmcnt(8)
    v_mfma_f32_32x32x16_bf16 v[32:47], v[88:91], v[92:95], v[32:47]
    s_waitcnt lgkmcnt(6)
    v_mfma_f32_32x32x16_bf16 v[32:47], v[96:99], v[100:103], v[32:47]
    s_waitcnt lgkmcnt(4)
    v_mfma_f32_32x32x16_bf16 v[32:47], v[104:107], v[108:111], v[32:47]
    s_waitcnt lgkmcnt(2)
    v_mfma_f32_32x32x16_bf16 v[32:47], v[112:115], v[116:119], v[32:47]
    s_waitcnt lgkmcnt(0)
    v_mfma_f32_32x32x16_bf16 v[32:47], v[120:123], v[124:127], v[32:47]
    s_nop 11
    v_add_f32 v32, v32, v13
    v_cvt_pk_bf16_f32 v52, v39, v38
    v_cvt_pk_bf16_f32 v53, v37, v36
    v_cvt_pk_bf16_f32 v54, v35, v34
    v_cvt_pk_bf16_f32 v55, v33, v32
    v_cvt_pk_bf16_f32 v56, v42, v42
    v_cvt_pk_bf16_f32 v57, v41, v41
    v_cvt_pk_bf16_f32 v58, v41, v40
    v_cvt_pk_bf16_f32 v59, v40, v40
    v_cvt_pk_bf16_f32 v60, v43, v44
    ds_write_b128 v10, v[52:55] offset:1024
    ds_write_b128 v10, v[56:59]
    ds_write_b16 v11, v60 offset:62
    ds_write_b16_d16_hi v11, v60 offset:46
    v_mov_b32 v60, 0
    v_and_b32 v61, 0xffff0000, v56
    v_mov_b32 v62, v56
    v_mov_b32 v63, v56
    s_mov_b32 exec_lo, 0
    s_mov_b32 exec_hi, 0x80000000
    ds_write_b128 v12, v[60:63] offset:33328
    s_mov_b64 exec, -1
    s_branch L_s_h2
L_s_h1:
    s_waitcnt lgkmcnt(0)
    s_barrier
    v_mov_b32 v16, 0
    v_mov_b32 v17, 0
    v_mov_b32 v18, 0
    v_mov_b32 v19, 0
    v_subrev_u32 v10, 11, v1
    v_lshrrev_b32 v11, 2, v10
    v_and_b32 v10, 3, v10
    v_lshl_add_u32 v10, v11, 3, v10
    v_add_u32 v10, 144, v10
    v_add_u32 v11, 129, v1
    v_cmp_gt_u32 vcc, 11, v1
    s_nop 1
    v_cndmask_b32 v10, v10, v11, vcc
    v_cmp_gt_u32 vcc, 7, v1
    s_nop 1
    v_cndmask_b32 v10, v10, v1, vcc
    v_lshlrev_b32 v10, 4, v10
    v_add_u32 v10, s50, v10
    s_mov_b64 exec, 0x7ffffff
    ds_write_b128 v10, v[16:19] offset:33216
    s_mov_b64 exec, -1
    v_mul_u32_u24 v14, 1280, v251
    v_and_b32 v15, 15, v1
    v_lshl_add_u32 v14, v15, 4, v14
    s_mul_i32 s9, s11, 5120
    s_add_u32 s9, s9, 143360
    v_add_u32 v14, s9, v14
    ds_write_b128 v14, v[16:19]
L_s_h2:
    s_waitcnt lgkmcnt(0)
    s_barrier
    s_lshl_b32 s9, s49, 10
    v_add_u32 v7, s9, v6
    ds_read_b128 v[64:67], v7 offset:33216
    ds_read_b64 v[68:69], v7 offset:33232
    ds_read_b128 v[72:75], v7 offset:34240
    ds_read_b64 v[76:77], v7 offset:34256
    s_mov_b32 s9, 0x05040100
    s_mov_b32 s10, 0x07060302
    s_waitcnt lgkmcnt(2)
    v_mov_b32 v96, v65
    v_mov_b32 v97, v66
    v_mov_b32 v98, v67
    v_mov_b32 v99, v68
    v_alignbit_b32 v100, v65, v64, 16
    v_alignbit_b32 v101, v66, v65, 16
    v_alignbit_b32 v102, v67, v66, 16
    v_alignbit_b32 v103, v68, v67, 16
    v_alignbit_b32 v104, v66, v65, 16
    v_alignbit_b32 v105, v67, v66, 16
    v_alignbit_b32 v106, v68, v67, 16
    v_alignbit_b32 v107, v69, v68, 16
    ds_write_b128 v7, v[96:99] offset:11072
    ds_write_b128 v7, v[100:103] offset:22144
    ds_write_b128 v7, v[104:107] offset:0
    s_cmp_eq_u32 s49, 0
    s_cbranch_scc1 L_s_c1
    s_waitcnt lgkmcnt(3)
    v_mov_b32 v112, v73
    v_mov_b32 v113, v74
    v_mov_b32 v114, v75
    v_mov_b32 v115, v76
    v_alignbit_b32 v116, v73, v72, 16
    v_alignbit_b32 v117, v74, v73, 16
    v_alignbit_b32 v118, v75, v74, 16
    v_alignbit_b32 v119, v76, v75, 16
    v_alignbit_b32 v120, v74, v73, 16
    v_alignbit_b32 v121, v75, v74, 16
    v_alignbit_b32 v122, v76, v75, 16
    v_alignbit_b32 v123, v77, v76, 16
    s_mov_b32 exec_hi, 0xfff
    ds_write_b128 v7, v[112:115] offset:12096
    ds_write_b128 v7, v[116:119] offset:23168
    ds_write_b128 v7, v[120:123] offset:1024
    s_mov_b64 exec, -1
    s_waitcnt vmcnt(0)
    s_branch L_s_c2
L_s_c1:
    s_waitcnt vmcnt(0)
L_s_c2:
    v_perm_b32 v16, v242, v240, s9
    v_perm_b32 v17, v246, v244, s9
    v_perm_b32 v18, v242, v240, s10
    v_perm_b32 v19, v246, v244, s10
    v_perm_b32 v20, v243, v241, s9
    v_perm_b32 v21, v247, v245, s9
    v_perm_b32 v22, v243, v241, s10
    v_perm_b32 v23, v247, v245, s10
    ds_write_b64 v248, v[16:17]
    ds_write_b64 v248, v[18:19] offset:5120
    ds_write_b64 v248, v[20:21] offset:10240
    ds_write_b64 v248, v[22:23] offset:15360
    s_cmp_lg_u32 s49, 0
    s_cbranch_scc1 L_s_help
    v_and_b32 v10, 3, v1
    v_mul_u32_u24 v10, 11072, v10
    v_bfe_u32 v12, v1, 2, 2
    v_lshlrev_b32 v13, 1, v251
    v_sub_u32 v13, v13, v12
    v_lshlrev_b32 v13, 3, v13
    v_add3_u32 v10, v10, v13, s50
    v_add_u32 v4, 24, v10
    s_mul_i32 s9, s11, 5120
    s_add_u32 s9, s9, 143360
    v_mul_u32_u24 v13, 1280, v251
    v_and_b32 v14, 15, v1
    v_lshl_add_u32 v13, v14, 4, v13
    v_add_u32 v7, s9, v13
    v_lshlrev_b32 v15, 6, v14
    v_and_b32 v9, 1, v251
    v_lshl_add_u32 v15, v9, 5, v15
    v_lshrrev_b32 v9, 1, v251
    v_lshl_add_u32 v15, v9, 4, v15
    s_add_u32 s10, s48, 2105344
    v_add_u32 v9, s10, v15
    v_lshl_add_u32 v13, v251, 3, v12
    v_lshlrev_b32 v13, 6, v13
    v_and_b32 v14, 3, v1
    v_lshl_add_u32 v13, v14, 3, v13
    s_mul_i32 s9, s11, 4224
    s_add_u32 s9, s9, 82176
    v_add_u32 v8, s9, v13
    s_setprio 2
    s_waitcnt lgkmcnt(0)
    s_barrier
    ds_read_b64 v[80:81], v4 offset:2144
    ds_read_b64 v[82:83], v4 offset:2152
    ds_read_b128 v[64:67], v7 offset:256
    ds_read_b128 v[68:71], v7 offset:512
    ds_read_b128 v[72:75], v7 offset:768
    ds_read_b128 v[76:79], v7 offset:1024
    ds_read_b64 v[84:85], v4 offset:2112
    ds_read_b64 v[86:87], v4 offset:2120
    ds_read_b64 v[88:89], v4 offset:1120
    ds_read_b64 v[90:91], v4 offset:1128
    ds_read_b64 v[92:93], v4 offset:1088
    ds_read_b64 v[94:95], v4 offset:1096
    ds_read_b64 v[128:129], v4 offset:96
    ds_read_b64 v[130:131], v4 offset:104
    ds_read_b64 v[132:133], v4 offset:64
    ds_read_b64 v[134:135], v4 offset:72
    s_waitcnt lgkmcnt(13)
    v_mfma_f32_16x16x32_bf16 v[32:35], v[80:83], v[64:67], 0
    ds_read_b64 v[112:113], v4 offset:2080
    ds_read_b64 v[114:115], v4 offset:2088
    s_waitcnt lgkmcnt(14)
    v_mfma_f32_16x16x32_bf16 v[36:39], v[80:83], v[68:71], 0
    ds_read_b128 v[96:99], v7 offset:240
    s_waitcnt lgkmcnt(14)
    v_mfma_f32_16x16x32_bf16 v[40:43], v[80:83], v[72:75], 0
    ds_read_b128 v[100:103], v7 offset:496
    s_waitcnt lgkmcnt(14)
    v_mfma_f32_16x16x32_bf16 v[44:47], v[80:83], v[76:79], 0
    ds_read_b128 v[104:107], v7 offset:752
    s_waitcnt lgkmcnt(13)
    v_mfma_f32_16x16x32_bf16 v[48:51], v[84:87], v[64:67], 0
    ds_read_b128 v[108:111], v7 offset:1008
    v_mfma_f32_16x16x32_bf16 v[52:55], v[84:87], v[68:71], 0
    ds_read_b64 v[116:117], v4 offset:2048
    v_mfma_f32_16x16x32_bf16 v[56:59], v[84:87], v[72:75], 0
    ds_read_b64 v[118:119], v4 offset:2056
    ds_read_b64 v[120:121], v4 offset:1056
    v_mfma_f32_16x16x32_bf16 v[60:63], v[84:87], v[76:79], 0
    ds_read_b64 v[122:123], v4 offset:1064
    s_waitcnt lgkmcnt(15)
    v_mfma_f32_16x16x32_bf16 v[36:39], v[88:91], v[64:67], v[36:39]
    ds_read_b64 v[124:125], v4 offset:1024
    v_mfma_f32_16x16x32_bf16 v[40:43], v[88:91], v[68:71], v[40:43]
    ds_read_b64 v[126:127], v4 offset:1032
    v_mfma_f32_16x16x32_bf16 v[44:47], v[88:91], v[72:75], v[44:47]
    ds_read_b64 v[136:137], v4 offset:32
    s_waitcnt lgkmcnt(15)
    v_mfma_f32_16x16x32_bf16 v[52:55], v[92:95], v[64:67], v[52:55]
    ds_read_b64 v[138:139], v4 offset:40
    v_mfma_f32_16x16x32_bf16 v[56:59], v[92:95], v[68:71], v[56:59]
    v_mfma_f32_16x16x32_bf16 v[60:63], v[92:95], v[72:75], v[60:63]
    v_mfma_f32_16x16x32_bf16 v[40:43], v[128:131], v[64:67], v[40:43]
    v_mfma_f32_16x16x32_bf16 v[44:47], v[128:131], v[68:71], v[44:47]
    s_waitcnt lgkmcnt(14)
    v_mfma_f32_16x16x32_bf16 v[56:59], v[132:135], v[64:67], v[56:59]
    v_mfma_f32_16x16x32_bf16 v[60:63], v[132:135], v[68:71], v[60:63]
    s_waitcnt lgkmcnt(11)
    v_mfma_f32_16x16x32_bf16 v[32:35], v[112:115], v[96:99], v[32:35]
    ds_read_b64 v[80:81], v4 offset:2016
    ds_read_b64 v[82:83], v4 offset:2024
    s_waitcnt lgkmcnt(12)
    v_mfma_f32_16x16x32_bf16 v[36:39], v[112:115], v[100:103], v[36:39]
    ds_read_b128 v[64:67], v7 offset:224
    s_waitcnt lgkmcnt(12)
    v_mfma_f32_16x16x32_bf16 v[40:43], v[112:115], v[104:107], v[40:43]
    ds_read_b128 v[68:71], v7 offset:480
    s_waitcnt lgkmcnt(12)
    v_mfma_f32_16x16x32_bf16 v[44:47], v[112:115], v[108:111], v[44:47]
    ds_read_b128 v[72:75], v7 offset:736
    s_waitcnt lgkmcnt(11)
    v_mfma_f32_16x16x32_bf16 v[48:51], v[116:119], v[96:99], v[48:51]
    ds_read_b128 v[76:79], v7 offset:992
    v_mfma_f32_16x16x32_bf16 v[52:55], v[116:119], v[100:103], v[52:55]
    ds_read_b64 v[84:85], v4 offset:1984
    ds_read_b64 v[86:87], v4 offset:1992
    v_mfma_f32_16x16x32_bf16 v[56:59], v[116:119], v[104:107], v[56:59]
    ds_read_b64 v[88:89], v4 offset:992
    v_mfma_f32_16x16x32_bf16 v[60:63], v[116:119], v[108:111], v[60:63]
    ds_read_b64 v[90:91], v4 offset:1000
    s_waitcnt lgkmcnt(14)
    v_mfma_f32_16x16x32_bf16 v[36:39], v[120:123], v[96:99], v[36:39]
    ds_read_b64 v[92:93], v4 offset:960
    v_mfma_f32_16x16x32_bf16 v[40:43], v[120:123], v[100:103], v[40:43]
    ds_read_b64 v[94:95], v4 offset:968
    v_mfma_f32_16x16x32_bf16 v[44:47], v[120:123], v[104:107], v[44:47]
    s_waitcnt lgkmcnt(14)
    v_mfma_f32_16x16x32_bf16 v[52:55], v[124:127], v[96:99], v[52:55]
    v_mfma_f32_16x16x32_bf16 v[56:59], v[124:127], v[100:103], v[56:59]
    v_mfma_f32_16x16x32_bf16 v[60:63], v[124:127], v[104:107], v[60:63]
    s_waitcnt lgkmcnt(12)
    v_mfma_f32_16x16x32_bf16 v[40:43], v[136:139], v[96:99], v[40:43]
    v_mfma_f32_16x16x32_bf16 v[44:47], v[136:139], v[100:103], v[44:47]
    s_waitcnt lgkmcnt(9)
    v_mfma_f32_16x16x32_bf16 v[32:35], v[80:83], v[64:67], v[32:35]
    ds_read_b64 v[112:113], v4 offset:1952
    ds_read_b64 v[114:115], v4 offset:1960
    s_waitcnt lgkmcnt(10)
    v_mfma_f32_16x16x32_bf16 v[36:39], v[80:83], v[68:71], v[36:39]
    ds_read_b128 v[96:99], v7 offset:208
    s_waitcnt lgkmcnt(10)
    v_mfma_f32_16x16x32_bf16 v[40:43], v[80:83], v[72:75], v[40:43]
    ds_read_b128 v[100:103], v7 offset:464
    ds_read_b128 v[104:107], v7 offset:720
    s_waitcnt lgkmcnt(11)
    v_mfma_f32_16x16x32_bf16 v[44:47], v[80:83], v[76:79], v[44:47]
    ds_read_b128 v[108:111], v7 offset:976
    s_waitcnt lgkmcnt(10)
    v_mfma_f32_16x16x32_bf16 v[48:51], v[84:87], v[64:67], v[48:51]
    ds_read_b64 v[116:117], v4 offset:1920
    ds_read_b64 v[118:119], v4 offset:1928
    v_mfma_f32_16x16x32_bf16 v[52:55], v[84:87], v[68:71], v[52:55]
    ds_read_b64 v[120:121], v4 offset:928
    v_mfma_f32_16x16x32_bf16 v[56:59], v[84:87], v[72:75], v[56:59]
    ds_read_b64 v[122:123], v4 offset:936
    ds_read_b64 v[124:125], v4 offset:896
    v_mfma_f32_16x16x32_bf16 v[60:63], v[84:87], v[76:79], v[60:63]
    ds_read_b64 v[126:127], v4 offset:904
    s_waitcnt lgkmcnt(14)
    v_mfma_f32_16x16x32_bf16 v[36:39], v[88:91], v[64:67], v[36:39]
    v_mfma_f32_16x16x32_bf16 v[40:43], v[88:91], v[68:71], v[40:43]
    v_mfma_f32_16x16x32_bf16 v[44:47], v[88:91], v[72:75], v[44:47]
    s_waitcnt lgkmcnt(12)
    v_mfma_f32_16x16x32_bf16 v[52:55], v[92:95], v[64:67], v[52:55]
    v_mfma_f32_16x16x32_bf16 v[56:59], v[92:95], v[68:71], v[56:59]
    v_mfma_f32_16x16x32_bf16 v[60:63], v[92:95], v[72:75], v[60:63]
    s_waitcnt lgkmcnt(9)
    v_mfma_f32_16x16x32_bf16 v[32:35], v[112:115], v[96:99], v[32:35]
    ds_read_b64 v[80:81], v4 offset:1888
    ds_read_b64 v[82:83], v4 offset:1896
    s_waitcnt lgkmcnt(10)
    v_mfma_f32_16x16x32_bf16 v[36:39], v[112:115], v[100:103], v[36:39]
    ds_read_b128 v[64:67], v7 offset:192
    s_waitcnt lgkmcnt(10)
    v_mfma_f32_16x16x32_bf16 v[40:43], v[112:115], v[104:107], v[40:43]
    ds_read_b128 v[68:71], v7 offset:448
    ds_read_b128 v[72:75], v7 offset:704
    s_waitcnt lgkmcnt(11)
    v_mfma_f32_16x16x32_bf16 v[44:47], v[112:115], v[108:111], v[44:47]
    ds_read_b128 v[76:79], v7 offset:960
    s_waitcnt lgkmcnt(10)
    v_mfma_f32_16x16x32_bf16 v[48:51], v[116:119], v[96:99], v[48:51]
    ds_read_b64 v[84:85], v4 offset:1856
    ds_read_b64 v[86:87], v4 offset:1864
    v_mfma_f32_16x16x32_bf16 v[52:55], v[116:119], v[100:103], v[52:55]
    ds_read_b64 v[88:89], v4 offset:864
    v_mfma_f32_16x16x32_bf16 v[56:59], v[116:119], v[104:107], v[56:59]
    ds_read_b64 v[90:91], v4 offset:872
    ds_read_b64 v[92:93], v4 offset:832
    v_mfma_f32_16x16x32_bf16 v[60:63], v[116:119], v[108:111], v[60:63]
    ds_read_b64 v[94:95], v4 offset:840
    s_waitcnt lgkmcnt(14)
    v_mfma_f32_16x16x32_bf16 v[36:39], v[120:123], v[96:99], v[36:39]
    v_mfma_f32_16x16x32_bf16 v[40:43], v[120:123], v[100:103], v[40:43]
    v_mfma_f32_16x16x32_bf16 v[44:47], v[120:123], v[104:107], v[44:47]
    s_waitcnt lgkmcnt(12)
    v_mfma_f32_16x16x32_bf16 v[52:55], v[124:127], v[96:99], v[52:55]
    v_mfma_f32_16x16x32_bf16 v[56:59], v[124:127], v[100:103], v[56:59]
    v_mfma_f32_16x16x32_bf16 v[60:63], v[124:127], v[104:107], v[60:63]
    s_waitcnt lgkmcnt(9)
    v_mfma_f32_16x16x32_bf16 v[32:35], v[80:83], v[64:67], v[32:35]
    ds_read_b64 v[112:113], v4 offset:1824
    ds_read_b64 v[114:115], v4 offset:1832
    s_waitcnt lgkmcnt(10)
    v_mfma_f32_16x16x32_bf16 v[36:39], v[80:83], v[68:71], v[36:39]
    ds_read_b128 v[96:99], v7 offset:176
    ds_read_b128 v[100:103], v7 offset:432
    s_waitcnt lgkmcnt(11)
    v_mfma_f32_16x16x32_bf16 v[40:43], v[80:83], v[72:75], v[40:43]
    ds_read_b128 v[104:107], v7 offset:688
    ds_read_b128 v[108:111], v7 offset:944
    s_waitcnt lgkmcnt(12)
    v_mfma_f32_16x16x32_bf16 v[44:47], v[80:83], v[76:79], v[44:47]
    ds_read_b64 v[116:117], v4 offset:1792
    s_waitcnt lgkmcnt(11)
    v_mfma_f32_16x16x32_bf16 v[48:51], v[84:87], v[64:67], v[48:51]
    ds_read_b64 v[118:119], v4 offset:1800
    ds_read_b64 v[120:121], v4 offset:800
    v_mfma_f32_16x16x32_bf16 v[52:55], v[84:87], v[68:71], v[52:55]
    ds_read_b64 v[122:123], v4 offset:808
    ds_read_b64 v[124:125], v4 offset:768
    v_mfma_f32_16x16x32_bf16 v[56:59], v[84:87], v[72:75], v[56:59]
    ds_read_b64 v[126:127], v4 offset:776
    ds_read_b64 v[144:145], v4 offset:2272
    v_mfma_f32_16x16x32_bf16 v[60:63], v[84:87], v[76:79], v[60:63]
    ds_read_b64 v[146:147], v4 offset:2280
    s_waitcnt lgkmcnt(15)
    v_mfma_f32_16x16x32_bf16 v[36:39], v[88:91], v[64:67], v[36:39]
    v_mfma_f32_16x16x32_bf16 v[40:43], v[88:91], v[68:71], v[40:43]
    v_mfma_f32_16x16x32_bf16 v[44:47], v[88:91], v[72:75], v[44:47]
    s_waitcnt lgkmcnt(14)
    v_mfma_f32_16x16x32_bf16 v[52:55], v[92:95], v[64:67], v[52:55]
    v_mfma_f32_16x16x32_bf16 v[56:59], v[92:95], v[68:71], v[56:59]
    v_mfma_f32_16x16x32_bf16 v[60:63], v[92:95], v[72:75], v[60:63]
    s_waitcnt lgkmcnt(11)
    v_mfma_f32_16x16x32_bf16 v[32:35], v[112:115], v[96:99], v[32:35]
    ds_read_b64 v[80:81], v4 offset:1760
    ds_read_b64 v[82:83], v4 offset:1768
    s_waitcnt lgkmcnt(12)
    v_mfma_f32_16x16x32_bf16 v[36:39], v[112:115], v[100:103], v[36:39]
    ds_read_b128 v[64:67], v7 offset:160
    ds_read_b128 v[68:71], v7 offset:416
    s_waitcnt lgkmcnt(13)
    v_mfma_f32_16x16x32_bf16 v[40:43], v[112:115], v[104:107], v[40:43]
    ds_read_b128 v[72:75], v7 offset:672
    ds_read_b128 v[76:79], v7 offset:928
    s_waitcnt lgkmcnt(14)
    v_mfma_f32_16x16x32_bf16 v[44:47], v[112:115], v[108:111], v[44:47]
    ds_read_b64 v[84:85], v4 offset:1728
    s_waitcnt lgkmcnt(13)
    v_mfma_f32_16x16x32_bf16 v[48:51], v[116:119], v[96:99], v[48:51]
    ds_read_b64 v[86:87], v4 offset:1736
    ds_read_b64 v[88:89], v4 offset:736
    v_mfma_f32_16x16x32_bf16 v[52:55], v[116:119], v[100:103], v[52:55]
    ds_read_b64 v[90:91], v4 offset:744
    ds_read_b64 v[92:93], v4 offset:704
    v_mfma_f32_16x16x32_bf16 v[56:59], v[116:119], v[104:107], v[56:59]
    ds_read_b64 v[94:95], v4 offset:712
    ds_read_b64 v[148:149], v4 offset:2240
    v_mfma_f32_16x16x32_bf16 v[60:63], v[116:119], v[108:111], v[60:63]
    ds_read_b64 v[150:151], v4 offset:2248
    s_waitcnt lgkmcnt(15)
    v_mfma_f32_16x16x32_bf16 v[36:39], v[120:123], v[96:99], v[36:39]
    v_mfma_f32_16x16x32_bf16 v[40:43], v[120:123], v[100:103], v[40:43]
    v_mfma_f32_16x16x32_bf16 v[44:47], v[120:123], v[104:107], v[44:47]
    v_mfma_f32_16x16x32_bf16 v[52:55], v[124:127], v[96:99], v[52:55]
    v_mfma_f32_16x16x32_bf16 v[56:59], v[124:127], v[100:103], v[56:59]
    v_mfma_f32_16x16x32_bf16 v[60:63], v[124:127], v[104:107], v[60:63]
    s_waitcnt lgkmcnt(11)
    v_mfma_f32_16x16x32_bf16 v[32:35], v[80:83], v[64:67], v[32:35]
    ds_read_b64 v[112:113], v4 offset:1696
    ds_read_b64 v[114:115], v4 offset:1704
    s_waitcnt lgkmcnt(12)
    v_mfma_f32_16x16x32_bf16 v[36:39], v[80:83], v[68:71], v[36:39]
    ds_read_b128 v[96:99], v7 offset:144
    ds_read_b128 v[100:103], v7 offset:400
    s_waitcnt lgkmcnt(13)
    v_mfma_f32_16x16x32_bf16 v[40:43], v[80:83], v[72:75], v[40:43]
    ds_read_b128 v[104:107], v7 offset:656
    ds_read_b128 v[108:111], v7 offset:912
    s_waitcnt lgkmcnt(14)
    v_mfma_f32_16x16x32_bf16 v[44:47], v[80:83], v[76:79], v[44:47]
    ds_read_b64 v[116:117], v4 offset:1664
    s_waitcnt lgkmcnt(13)
    v_mfma_f32_16x16x32_bf16 v[48:51], v[84:87], v[64:67], v[48:51]
    ds_read_b64 v[118:119], v4 offset:1672
    ds_read_b64 v[120:121], v4 offset:672
    v_mfma_f32_16x16x32_bf16 v[52:55], v[84:87], v[68:71], v[52:55]
    ds_read_b64 v[122:123], v4 offset:680
    ds_read_b64 v[124:125], v4 offset:640
    v_mfma_f32_16x16x32_bf16 v[56:59], v[84:87], v[72:75], v[56:59]
    ds_read_b64 v[126:127], v4 offset:648
    ds_read_b64 v[152:153], v4 offset:2400
    v_mfma_f32_16x16x32_bf16 v[60:63], v[84:87], v[76:79], v[60:63]
    ds_read_b64 v[154:155], v4 offset:2408
    s_waitcnt lgkmcnt(15)
    v_mfma_f32_16x16x32_bf16 v[36:39], v[88:91], v[64:67], v[36:39]
    v_mfma_f32_16x16x32_bf16 v[40:43], v[88:91], v[68:71], v[40:43]
    v_mfma_f32_16x16x32_bf16 v[44:47], v[88:91], v[72:75], v[44:47]
    v_mfma_f32_16x16x32_bf16 v[52:55], v[92:95], v[64:67], v[52:55]
    v_mfma_f32_16x16x32_bf16 v[56:59], v[92:95], v[68:71], v[56:59]
    v_mfma_f32_16x16x32_bf16 v[60:63], v[92:95], v[72:75], v[60:63]
    s_waitcnt lgkmcnt(11)
    v_mfma_f32_16x16x32_bf16 v[32:35], v[112:115], v[96:99], v[32:35]
    ds_read_b64 v[80:81], v4 offset:1632
    ds_read_b64 v[82:83], v4 offset:1640
    s_waitcnt lgkmcnt(12)
    v_mfma_f32_16x16x32_bf16 v[36:39], v[112:115], v[100:103], v[36:39]
    ds_read_b128 v[64:67], v7 offset:128
    ds_read_b128 v[68:71], v7 offset:384
    s_waitcnt lgkmcnt(13)
    v_mfma_f32_16x16x32_bf16 v[40:43], v[112:115], v[104:107], v[40:43]
    ds_read_b128 v[72:75], v7 offset:640
    ds_read_b128 v[76:79], v7 offset:896
    s_waitcnt lgkmcnt(14)
    v_mfma_f32_16x16x32_bf16 v[44:47], v[112:115], v[108:111], v[44:47]
    ds_read_b64 v[84:85], v4 offset:1600
    s_waitcnt lgkmcnt(13)
    v_mfma_f32_16x16x32_bf16 v[48:51], v[116:119], v[96:99], v[48:51]
    ds_read_b64 v[86:87], v4 offset:1608
    ds_read_b64 v[88:89], v4 offset:608
    v_mfma_f32_16x16x32_bf16 v[52:55], v[116:119], v[100:103], v[52:55]
    ds_read_b64 v[90:91], v4 offset:616
    ds_read_b64 v[92:93], v4 offset:576
    v_mfma_f32_16x16x32_bf16 v[56:59], v[116:119], v[104:107], v[56:59]
    ds_read_b64 v[94:95], v4 offset:584
    ds_read_b64 v[156:157], v4 offset:2368
    v_mfma_f32_16x16x32_bf16 v[60:63], v[116:119], v[108:111], v[60:63]
    ds_read_b64 v[158:159], v4 offset:2376
    s_waitcnt lgkmcnt(15)
    v_mfma_f32_16x16x32_bf16 v[36:39], v[120:123], v[96:99], v[36:39]
    v_mfma_f32_16x16x32_bf16 v[40:43], v[120:123], v[100:103], v[40:43]
    v_mfma_f32_16x16x32_bf16 v[44:47], v[120:123], v[104:107], v[44:47]
    v_mfma_f32_16x16x32_bf16 v[52:55], v[124:127], v[96:99], v[52:55]
    v_mfma_f32_16x16x32_bf16 v[56:59], v[124:127], v[100:103], v[56:59]
    v_mfma_f32_16x16x32_bf16 v[60:63], v[124:127], v[104:107], v[60:63]
    s_waitcnt lgkmcnt(11)
    v_mfma_f32_16x16x32_bf16 v[32:35], v[80:83], v[64:67], v[32:35]
    ds_read_b64 v[112:113], v4 offset:1568
    ds_read_b64 v[114:115], v4 offset:1576
    s_waitcnt lgkmcnt(12)
    v_mfma_f32_16x16x32_bf16 v[36:39], v[80:83], v[68:71], v[36:39]
    ds_read_b128 v[96:99], v7 offset:112
    ds_read_b128 v[100:103], v7 offset:368
    s_waitcnt lgkmcnt(13)
    v_mfma_f32_16x16x32_bf16 v[40:43], v[80:83], v[72:75], v[40:43]
    ds_read_b128 v[104:107], v7 offset:624
    ds_read_b128 v[108:111], v7 offset:880
    s_waitcnt lgkmcnt(14)
    v_mfma_f32_16x16x32_bf16 v[44:47], v[80:83], v[76:79], v[44:47]
    ds_read_b64 v[116:117], v4 offset:1536
    s_waitcnt lgkmcnt(13)
    v_mfma_f32_16x16x32_bf16 v[48:51], v[84:87], v[64:67], v[48:51]
    ds_read_b64 v[118:119], v4 offset:1544
    ds_read_b64 v[120:121], v4 offset:544
    v_mfma_f32_16x16x32_bf16 v[52:55], v[84:87], v[68:71], v[52:55]
    ds_read_b64 v[122:123], v4 offset:552
    ds_read_b64 v[124:125], v4 offset:512
    v_mfma_f32_16x16x32_bf16 v[56:59], v[84:87], v[72:75], v[56:59]
    ds_read_b64 v[126:127], v4 offset:520
    ds_read_b64 v[160:161], v4 offset:2528
    v_mfma_f32_16x16x32_bf16 v[60:63], v[84:87], v[76:79], v[60:63]
    ds_read_b64 v[162:163], v4 offset:2536
    s_waitcnt lgkmcnt(15)
    v_mfma_f32_16x16x32_bf16 v[36:39], v[88:91], v[64:67], v[36:39]
    v_mfma_f32_16x16x32_bf16 v[40:43], v[88:91], v[68:71], v[40:43]
    v_mfma_f32_16x16x32_bf16 v[44:47], v[88:91], v[72:75], v[44:47]
    v_mfma_f32_16x16x32_bf16 v[52:55], v[92:95], v[64:67], v[52:55]
    v_mfma_f32_16x16x32_bf16 v[56:59], v[92:95], v[68:71], v[56:59]
    v_mfma_f32_16x16x32_bf16 v[60:63], v[92:95], v[72:75], v[60:63]
    s_waitcnt lgkmcnt(11)
    v_mfma_f32_16x16x32_bf16 v[32:35], v[112:115], v[96:99], v[32:35]
    ds_read_b64 v[80:81], v4 offset:1504
    ds_read_b64 v[82:83], v4 offset:1512
    s_waitcnt lgkmcnt(12)
    v_mfma_f32_16x16x32_bf16 v[36:39], v[112:115], v[100:103], v[36:39]
    ds_read_b128 v[64:67], v7 offset:96
    ds_read_b128 v[68:71], v7 offset:352
    s_waitcnt lgkmcnt(13)
    v_mfma_f32_16x16x32_bf16 v[40:43], v[112:115], v[104:107], v[40:43]
    ds_read_b128 v[72:75], v7 offset:608
    ds_read_b128 v[76:79], v7 offset:864
    s_waitcnt lgkmcnt(14)
    v_mfma_f32_16x16x32_bf16 v[44:47], v[112:115], v[108:111], v[44:47]
    ds_read_b64 v[84:85], v4 offset:1472
    s_waitcnt lgkmcnt(13)
    v_mfma_f32_16x16x32_bf16 v[48:51], v[116:119], v[96:99], v[48:51]
    ds_read_b64 v[86:87], v4 offset:1480
    ds_read_b64 v[88:89], v4 offset:480
    v_mfma_f32_16x16x32_bf16 v[52:55], v[116:119], v[100:103], v[52:55]
    ds_read_b64 v[90:91], v4 offset:488
    ds_read_b64 v[92:93], v4 offset:448
    v_mfma_f32_16x16x32_bf16 v[56:59], v[116:119], v[104:107], v[56:59]
    ds_read_b64 v[94:95], v4 offset:456
    ds_read_b64 v[164:165], v4 offset:2496
    v_mfma_f32_16x16x32_bf16 v[60:63], v[116:119], v[108:111], v[60:63]
    ds_read_b64 v[166:167], v4 offset:2504
    s_waitcnt lgkmcnt(15)
    v_mfma_f32_16x16x32_bf16 v[36:39], v[120:123], v[96:99], v[36:39]
    v_mfma_f32_16x16x32_bf16 v[40:43], v[120:123], v[100:103], v[40:43]
    v_mfma_f32_16x16x32_bf16 v[44:47], v[120:123], v[104:107], v[44:47]
    v_mfma_f32_16x16x32_bf16 v[52:55], v[124:127], v[96:99], v[52:55]
    v_mfma_f32_16x16x32_bf16 v[56:59], v[124:127], v[100:103], v[56:59]
    v_mfma_f32_16x16x32_bf16 v[60:63], v[124:127], v[104:107], v[60:63]
    s_waitcnt lgkmcnt(11)
    v_mfma_f32_16x16x32_bf16 v[32:35], v[80:83], v[64:67], v[32:35]
    ds_read_b64 v[112:113], v4 offset:1440
    ds_read_b64 v[114:115], v4 offset:1448
    s_waitcnt lgkmcnt(12)
    v_mfma_f32_16x16x32_bf16 v[36:39], v[80:83], v[68:71], v[36:39]
    ds_read_b128 v[96:99], v7 offset:80
    ds_read_b128 v[100:103], v7 offset:336
    s_waitcnt lgkmcnt(13)
    v_mfma_f32_16x16x32_bf16 v[40:43], v[80:83], v[72:75], v[40:43]
    ds_read_b128 v[104:107], v7 offset:592
    ds_read_b128 v[108:111], v7 offset:848
    s_waitcnt lgkmcnt(14)
    v_mfma_f32_16x16x32_bf16 v[44:47], v[80:83], v[76:79], v[44:47]
    ds_read_b64 v[116:117], v4 offset:1408
    s_waitcnt lgkmcnt(13)
    v_mfma_f32_16x16x32_bf16 v[48:51], v[84:87], v[64:67], v[48:51]
    ds_read_b64 v[118:119], v4 offset:1416
    ds_read_b64 v[120:121], v4 offset:416
    v_mfma_f32_16x16x32_bf16 v[52:55], v[84:87], v[68:71], v[52:55]
    ds_read_b64 v[122:123], v4 offset:424
    ds_read_b64 v[124:125], v4 offset:384
    v_mfma_f32_16x16x32_bf16 v[56:59], v[84:87], v[72:75], v[56:59]
    ds_read_b64 v[126:127], v4 offset:392
    ds_read_b64 v[168:169], v4 offset:2656
    v_mfma_f32_16x16x32_bf16 v[60:63], v[84:87], v[76:79], v[60:63]
    ds_read_b64 v[170:171], v4 offset:2664
    s_waitcnt lgkmcnt(15)
    v_mfma_f32_16x16x32_bf16 v[36:39], v[88:91], v[64:67], v[36:39]
    v_mfma_f32_16x16x32_bf16 v[40:43], v[88:91], v[68:71], v[40:43]
    v_mfma_f32_16x16x32_bf16 v[44:47], v[88:91], v[72:75], v[44:47]
    v_mfma_f32_16x16x32_bf16 v[52:55], v[92:95], v[64:67], v[52:55]
    v_mfma_f32_16x16x32_bf16 v[56:59], v[92:95], v[68:71], v[56:59]
    v_mfma_f32_16x16x32_bf16 v[60:63], v[92:95], v[72:75], v[60:63]
    s_barrier
    s_waitcnt lgkmcnt(11)
    v_mfma_f32_16x16x32_bf16 v[32:35], v[112:115], v[96:99], v[32:35]
    ds_read_b64 v[80:81], v4 offset:1376
    ds_read_b64 v[82:83], v4 offset:1384
    s_waitcnt lgkmcnt(12)
    v_mfma_f32_16x16x32_bf16 v[36:39], v[112:115], v[100:103], v[36:39]
    ds_read_b128 v[64:67], v7 offset:64
    ds_read_b128 v[68:71], v7 offset:320
    s_waitcnt lgkmcnt(13)
    v_mfma_f32_16x16x32_bf16 v[40:43], v[112:115], v[104:107], v[40:43]
    ds_read_b128 v[72:75], v7 offset:576
    ds_read_b128 v[76:79], v7 offset:832
    s_waitcnt lgkmcnt(14)
    v_mfma_f32_16x16x32_bf16 v[44:47], v[112:115], v[108:111], v[44:47]
    ds_read_b64 v[84:85], v4 offset:1344
    s_waitcnt lgkmcnt(13)
    v_mfma_f32_16x16x32_bf16 v[48:51], v[116:119], v[96:99], v[48:51]
    ds_read_b64 v[86:87], v4 offset:1352
    ds_read_b64 v[88:89], v4 offset:352
    v_mfma_f32_16x16x32_bf16 v[52:55], v[116:119], v[100:103], v[52:55]
    ds_read_b64 v[90:91], v4 offset:360
    ds_read_b64 v[92:93], v4 offset:320
    v_mfma_f32_16x16x32_bf16 v[56:59], v[116:119], v[104:107], v[56:59]
    ds_read_b64 v[94:95], v4 offset:328
    ds_read_b64 v[172:173], v4 offset:2624
    v_mfma_f32_16x16x32_bf16 v[60:63], v[116:119], v[108:111], v[60:63]
    ds_read_b64 v[174:175], v4 offset:2632
    s_waitcnt lgkmcnt(15)
    v_mfma_f32_16x16x32_bf16 v[36:39], v[120:123], v[96:99], v[36:39]
    v_mfma_f32_16x16x32_bf16 v[40:43], v[120:123], v[100:103], v[40:43]
    v_mfma_f32_16x16x32_bf16 v[44:47], v[120:123], v[104:107], v[44:47]
    v_mfma_f32_16x16x32_bf16 v[52:55], v[124:127], v[96:99], v[52:55]
    v_mfma_f32_16x16x32_bf16 v[56:59], v[124:127], v[100:103], v[56:59]
    v_mfma_f32_16x16x32_bf16 v[60:63], v[124:127], v[104:107], v[60:63]
    s_waitcnt lgkmcnt(11)
    v_mfma_f32_16x16x32_bf16 v[32:35], v[80:83], v[64:67], v[32:35]
    ds_read_b64 v[112:113], v4 offset:1312
    ds_read_b64 v[114:115], v4 offset:1320
    s_waitcnt lgkmcnt(12)
    v_mfma_f32_16x16x32_bf16 v[36:39], v[80:83], v[68:71], v[36:39]
    ds_read_b128 v[96:99], v7 offset:48
    ds_read_b128 v[100:103], v7 offset:304
    s_waitcnt lgkmcnt(13)
    v_mfma_f32_16x16x32_bf16 v[40:43], v[80:83], v[72:75], v[40:43]
    ds_read_b128 v[104:107], v7 offset:560
    ds_read_b128 v[108:111], v7 offset:816
    s_waitcnt lgkmcnt(14)
    v_mfma_f32_16x16x32_bf16 v[44:47], v[80:83], v[76:79], v[44:47]
    ds_read_b64 v[116:117], v4 offset:1280
    ds_read_b64 v[118:119], v4 offset:1288
    s_waitcnt lgkmcnt(14)
    v_mfma_f32_16x16x32_bf16 v[48:51], v[84:87], v[64:67], v[48:51]
    ds_read_b64 v[120:121], v4 offset:288
    ds_read_b64 v[122:123], v4 offset:296
    v_mfma_f32_16x16x32_bf16 v[52:55], v[84:87], v[68:71], v[52:55]
    ds_read_b64 v[124:125], v4 offset:256
    ds_read_b64 v[126:127], v4 offset:264
    v_mfma_f32_16x16x32_bf16 v[56:59], v[84:87], v[72:75], v[56:59]
    ds_read_b64_tr_b16 v[176:177], v8 offset:48
    ds_read_b64_tr_b16 v[178:179], v8 offset:304
    v_mfma_f32_16x16x32_bf16 v[60:63], v[84:87], v[76:79], v[60:63]
    ds_read_b64_tr_b16 v[180:181], v8 offset:80
    ds_read_b64_tr_b16 v[182:183], v8 offset:336
    s_waitcnt lgkmcnt(15)
    v_mfma_f32_16x16x32_bf16 v[36:39], v[88:91], v[64:67], v[36:39]
    v_mfma_f32_16x16x32_bf16 v[40:43], v[88:91], v[68:71], v[40:43]
    v_mfma_f32_16x16x32_bf16 v[44:47], v[88:91], v[72:75], v[44:47]
    v_mfma_f32_16x16x32_bf16 v[52:55], v[92:95], v[64:67], v[52:55]
    v_mfma_f32_16x16x32_bf16 v[56:59], v[92:95], v[68:71], v[56:59]
    v_mfma_f32_16x16x32_bf16 v[60:63], v[92:95], v[72:75], v[60:63]
    s_waitcnt lgkmcnt(13)
    v_mfma_f32_16x16x32_bf16 v[32:35], v[112:115], v[96:99], v[32:35]
    ds_read_b64 v[80:81], v4 offset:1248
    ds_read_b64 v[82:83], v4 offset:1256
    s_waitcnt lgkmcnt(14)
    v_mfma_f32_16x16x32_bf16 v[36:39], v[112:115], v[100:103], v[36:39]
    ds_read_b128 v[64:67], v7 offset:32
    ds_read_b128 v[68:71], v7 offset:288
    s_waitcnt lgkmcnt(15)
    v_mfma_f32_16x16x32_bf16 v[40:43], v[112:115], v[104:107], v[40:43]
    ds_read_b128 v[72:75], v7 offset:544
    ds_read_b128 v[76:79], v7 offset:800
    s_waitcnt lgkmcnt(15)
    v_mfma_f32_16x16x32_bf16 v[44:47], v[112:115], v[108:111], v[44:47]
    ds_read_b64 v[84:85], v4 offset:1216
    ds_read_b64 v[86:87], v4 offset:1224
    s_waitcnt lgkmcnt(15)
    v_mfma_f32_16x16x32_bf16 v[48:51], v[116:119], v[96:99], v[48:51]
    ds_read_b64 v[88:89], v4 offset:224
    ds_read_b64 v[90:91], v4 offset:232
    v_mfma_f32_16x16x32_bf16 v[52:55], v[116:119], v[100:103], v[52:55]
    ds_read_b64 v[92:93], v4 offset:192
    ds_read_b64 v[94:95], v4 offset:200
    v_mfma_f32_16x16x32_bf16 v[56:59], v[116:119], v[104:107], v[56:59]
    ds_read_b64_tr_b16 v[184:185], v8 offset:2144
    ds_read_b64_tr_b16 v[186:187], v8 offset:2400
    v_mfma_f32_16x16x32_bf16 v[60:63], v[116:119], v[108:111], v[60:63]
    ds_read_b64_tr_b16 v[188:189], v8 offset:2176
    ds_read_b64_tr_b16 v[190:191], v8 offset:2432
    s_waitcnt lgkmcnt(15)
    v_mfma_f32_16x16x32_bf16 v[36:39], v[120:123], v[96:99], v[36:39]
    v_mfma_f32_16x16x32_bf16 v[40:43], v[120:123], v[100:103], v[40:43]
    v_mfma_f32_16x16x32_bf16 v[44:47], v[120:123], v[104:107], v[44:47]
    v_mfma_f32_16x16x32_bf16 v[52:55], v[124:127], v[96:99], v[52:55]
    v_mfma_f32_16x16x32_bf16 v[56:59], v[124:127], v[100:103], v[56:59]
    v_mfma_f32_16x16x32_bf16 v[60:63], v[124:127], v[104:107], v[60:63]
    s_waitcnt lgkmcnt(13)
    v_mfma_f32_16x16x32_bf16 v[32:35], v[80:83], v[64:67], v[32:35]
    ds_read_b64 v[112:113], v4 offset:1184
    ds_read_b64 v[114:115], v4 offset:1192
    s_waitcnt lgkmcnt(14)
    v_mfma_f32_16x16x32_bf16 v[36:39], v[80:83], v[68:71], v[36:39]
    ds_read_b128 v[96:99], v7 offset:16
    ds_read_b128 v[100:103], v7 offset:272
    s_waitcnt lgkmcnt(15)
    v_mfma_f32_16x16x32_bf16 v[40:43], v[80:83], v[72:75], v[40:43]
    ds_read_b128 v[104:107], v7 offset:528
    ds_read_b128 v[108:111], v7 offset:784
    s_waitcnt lgkmcnt(15)
    v_mfma_f32_16x16x32_bf16 v[44:47], v[80:83], v[76:79], v[44:47]
    ds_read_b64 v[116:117], v4 offset:1152
    ds_read_b64 v[118:119], v4 offset:1160
    s_waitcnt lgkmcnt(15)
    v_mfma_f32_16x16x32_bf16 v[48:51], v[84:87], v[64:67], v[48:51]
    ds_read_b64 v[120:121], v4 offset:160
    ds_read_b64 v[122:123], v4 offset:168
    v_mfma_f32_16x16x32_bf16 v[52:55], v[84:87], v[68:71], v[52:55]
    ds_read_b64 v[124:125], v4 offset:128
    ds_read_b64 v[126:127], v4 offset:136
    v_mfma_f32_16x16x32_bf16 v[56:59], v[84:87], v[72:75], v[56:59]
    ds_read_b64_tr_b16 v[192:193], v8 offset:16
    ds_read_b64_tr_b16 v[194:195], v8 offset:272
    v_mfma_f32_16x16x32_bf16 v[60:63], v[84:87], v[76:79], v[60:63]
    ds_read_b64_tr_b16 v[196:197], v8 offset:48
    ds_read_b64_tr_b16 v[198:199], v8 offset:304
    s_waitcnt lgkmcnt(15)
    v_mfma_f32_16x16x32_bf16 v[36:39], v[88:91], v[64:67], v[36:39]
    v_mfma_f32_16x16x32_bf16 v[40:43], v[88:91], v[68:71], v[40:43]
    v_mfma_f32_16x16x32_bf16 v[44:47], v[88:91], v[72:75], v[44:47]
    v_mfma_f32_16x16x32_bf16 v[52:55], v[92:95], v[64:67], v[52:55]
    v_mfma_f32_16x16x32_bf16 v[56:59], v[92:95], v[68:71], v[56:59]
    v_mfma_f32_16x16x32_bf16 v[60:63], v[92:95], v[72:75], v[60:63]
    s_waitcnt lgkmcnt(13)
    v_mfma_f32_16x16x32_bf16 v[32:35], v[112:115], v[96:99], v[32:35]
    ds_read_b64_tr_b16 v[200:201], v8 offset:2112
    s_waitcnt lgkmcnt(13)
    v_mfma_f32_16x16x32_bf16 v[36:39], v[112:115], v[100:103], v[36:39]
    s_waitcnt lgkmcnt(12)
    v_mfma_f32_16x16x32_bf16 v[40:43], v[112:115], v[104:107], v[40:43]
    ds_read_b64_tr_b16 v[202:203], v8 offset:2368
    s_waitcnt lgkmcnt(12)
    v_mfma_f32_16x16x32_bf16 v[44:47], v[112:115], v[108:111], v[44:47]
    s_waitcnt lgkmcnt(10)
    v_mfma_f32_16x16x32_bf16 v[48:51], v[116:119], v[96:99], v[48:51]
    ds_read_b64_tr_b16 v[204:205], v8 offset:2144
    v_mfma_f32_16x16x32_bf16 v[52:55], v[116:119], v[100:103], v[52:55]
    v_mfma_f32_16x16x32_bf16 v[56:59], v[116:119], v[104:107], v[56:59]
    ds_read_b64_tr_b16 v[206:207], v8 offset:2400
    v_mfma_f32_16x16x32_bf16 v[60:63], v[116:119], v[108:111], v[60:63]
    s_waitcnt lgkmcnt(10)
    v_mfma_f32_16x16x32_bf16 v[36:39], v[120:123], v[96:99], v[36:39]
    v_mfma_f32_16x16x32_bf16 v[40:43], v[120:123], v[100:103], v[40:43]
    v_mfma_f32_16x16x32_bf16 v[44:47], v[120:123], v[104:107], v[44:47]
    s_waitcnt lgkmcnt(8)
    v_mfma_f32_16x16x32_bf16 v[52:55], v[124:127], v[96:99], v[52:55]
    v_mfma_f32_16x16x32_bf16 v[56:59], v[124:127], v[100:103], v[56:59]
    v_mfma_f32_16x16x32_bf16 v[60:63], v[124:127], v[104:107], v[60:63]
    v_mfma_f32_16x16x32_bf16 v[40:43], v[176:179], v[144:147], v[40:43]
    v_mfma_f32_16x16x32_bf16 v[44:47], v[176:179], v[148:151], v[44:47]
    v_mfma_f32_16x16x32_bf16 v[56:59], v[180:183], v[144:147], v[56:59]
    v_mfma_f32_16x16x32_bf16 v[60:63], v[180:183], v[148:151], v[60:63]
    v_mfma_f32_16x16x32_bf16 v[40:43], v[184:187], v[152:155], v[40:43]
    v_mfma_f32_16x16x32_bf16 v[44:47], v[184:187], v[156:159], v[44:47]
    v_mfma_f32_16x16x32_bf16 v[56:59], v[188:191], v[152:155], v[56:59]
    v_mfma_f32_16x16x32_bf16 v[60:63], v[188:191], v[156:159], v[60:63]
    s_waitcnt lgkmcnt(6)
    v_mfma_f32_16x16x32_bf16 v[40:43], v[192:195], v[160:163], v[40:43]
    v_mfma_f32_16x16x32_bf16 v[44:47], v[192:195], v[164:167], v[44:47]
    s_waitcnt lgkmcnt(4)
    v_mfma_f32_16x16x32_bf16 v[56:59], v[196:199], v[160:163], v[56:59]
    v_mfma_f32_16x16x32_bf16 v[60:63], v[196:199], v[164:167], v[60:63]
    s_waitcnt lgkmcnt(2)
    v_mfma_f32_16x16x32_bf16 v[40:43], v[200:203], v[168:171], v[40:43]
    v_mfma_f32_16x16x32_bf16 v[44:47], v[200:203], v[172:175], v[44:47]
    s_waitcnt lgkmcnt(0)
    v_mfma_f32_16x16x32_bf16 v[56:59], v[204:207], v[168:171], v[56:59]
    v_mfma_f32_16x16x32_bf16 v[60:63], v[204:207], v[172:175], v[60:63]
    v_cvt_pk_bf16_f32 v64, v32, v33
    v_cvt_pk_bf16_f32 v65, v34, v35
    v_cvt_pk_bf16_f32 v66, v48, v49
    v_cvt_pk_bf16_f32 v67, v50, v51
    v_cvt_pk_bf16_f32 v68, v36, v37
    v_cvt_pk_bf16_f32 v69, v38, v39
    v_cvt_pk_bf16_f32 v70, v52, v53
    v_cvt_pk_bf16_f32 v71, v54, v55
    v_cvt_pk_bf16_f32 v72, v40, v41
    v_cvt_pk_bf16_f32 v73, v42, v43
    v_cvt_pk_bf16_f32 v74, v56, v57
    v_cvt_pk_bf16_f32 v75, v58, v59
    v_cvt_pk_bf16_f32 v76, v44, v45
    v_cvt_pk_bf16_f32 v77, v46, v47
    v_cvt_pk_bf16_f32 v78, v60, v61
    v_cvt_pk_bf16_f32 v79, v62, v63
    v_permlane16_swap_b32 v64, v66
    v_permlane16_swap_b32 v65, v67
    global_store_dwordx4 v9, v[64:67], s[34:35] offset:0 sc1
    v_permlane16_swap_b32 v68, v70
    v_permlane16_swap_b32 v69, v71
    global_store_dwordx4 v9, v[68:71], s[34:35] offset:1024 sc1
    v_permlane16_swap_b32 v72, v74
    v_permlane16_swap_b32 v73, v75
    global_store_dwordx4 v9, v[72:75], s[34:35] offset:2048 sc1
    v_permlane16_swap_b32 v76, v78
    v_permlane16_swap_b32 v77, v79
    global_store_dwordx4 v9, v[76:79], s[34:35] offset:3072 sc1
    s_setprio 0
    s_lshr_b32 s9, s47, 2
    s_mul_i32 s9, s9, 3840
    s_and_b32 s10, s47, 3
    s_lshl_b32 s10, s10, 7
    s_add_u32 s9, s9, s10
    s_lshl_b32 s10, s11, 2
    s_add_u32 s9, s9, s10
    s_add_u32 s15, s9, 4262656
    s_call_b64 s[100:101], L_setup
    s_nop 0
    s_waitcnt vmcnt(0)
    v_mov_b32 v22, s15
    v_mov_b32 v23, 1
    s_mov_b64 exec, 1
    global_store_dword v22, v23, s[34:35] sc1
    s_mov_b64 exec, -1
    s_barrier
    s_branch L_p2
L_s_help:
    s_waitcnt lgkmcnt(0)
    s_barrier
    v_and_b32 v232, 3, v1
    v_lshlrev_b32 v232, 21, v232
    v_add_u32 v232, 4096, v232
    v_cmp_eq_u32 vcc, 4096, v232
    s_nop 1
    v_cndmask_b32 v232, v232, 0, vcc
    v_min_u32 v232, 4227072, v232
    v_or_b32 v233, 0x6000, v232
    v_cmp_lt_u32 vcc, 4194304, v232
    s_nop 1
    v_cndmask_b32 v232, v232, v233, vcc
    global_load_dword v233, v232, s[34:35]
    s_lshl_b32 s9, s62, 15
    s_lshl_b32 s10, s63, 8
    s_add_u32 s9, s9, s10
    v_mov_b32 v234, s9
    global_load_dword v235, v234, s[30:31]
    v_mov_b32 v234, 0
    global_load_dword v236, v234, s[12:13]
    v_and_b32 v202, 7, v1
    v_lshlrev_b32 v202, 2, v202
    global_load_dword v203, v202, s[32:33] sc1
    v_lshlrev_b32 v20, 4, v1
    v_add_u32 v21, s48, v20
    global_load_dwordx4 v[204:207], v20, s[28:29]
    global_load_dwordx4 v[208:211], v21, s[4:5]
    global_load_dwordx4 v[212:215], v21, s[4:5] offset:1024
    global_load_dwordx4 v[216:219], v21, s[4:5] offset:2048
    global_load_dwordx4 v[220:223], v21, s[4:5] offset:3072
    s_lshr_b32 s9, s46, 2
    s_cmp_lg_u32 s9, 0
    s_cbranch_scc1 Lpw_10_0
    s_add_u32 m0, s97, 65536
    s_add_u32 s9, s96, 393216
    buffer_load_dwordx4 v253, s[92:95], s9 offen lds
    s_add_u32 m0, s97, 66560
    s_add_u32 s9, s9, 8192
    buffer_load_dwordx4 v253, s[92:95], s9 offen lds
    s_add_u32 m0, s97, 73728
    s_add_u32 s9, s96, 458752
    buffer_load_dwordx4 v253, s[92:95], s9 offen lds
    s_add_u32 m0, s97, 74752
    s_add_u32 s9, s9, 8192
    buffer_load_dwordx4 v253, s[92:95], s9 offen lds
Lpw_10_0:
    s_lshr_b32 s9, s46, 2
    s_cmp_lg_u32 s9, 1
    s_cbranch_scc1 Lpw_10_1
    s_add_u32 m0, s97, 65536
    s_add_u32 s9, s96, 262272
    buffer_load_dwordx4 v253, s[92:95], s9 offen lds
    s_add_u32 m0, s97, 66560
    s_add_u32 s9, s9, 8192
    buffer_load_dwordx4 v253, s[92:95], s9 offen lds
    s_add_u32 m0, s97, 73728
    s_add_u32 s9, s96, 327808
    buffer_load_dwordx4 v253, s[92:95], s9 offen lds
    s_add_u32 m0, s97, 74752
    s_add_u32 s9, s9, 8192
    buffer_load_dwordx4 v253, s[92:95], s9 offen lds
Lpw_10_1:
    s_lshr_b32 s9, s46, 2
    s_cmp_lg_u32 s9, 2
    s_cbranch_scc1 Lpw_10_2
    s_add_u32 m0, s97, 65536
    s_add_u32 s9, s96, 393344
    buffer_load_dwordx4 v253, s[92:95], s9 offen lds
    s_add_u32 m0, s97, 66560
    s_add_u32 s9, s9, 8192
    buffer_load_dwordx4 v253, s[92:95], s9 offen lds
    s_add_u32 m0, s97, 73728
    s_add_u32 s9, s96, 458880
    buffer_load_dwordx4 v253, s[92:95], s9 offen lds
    s_add_u32 m0, s97, 74752
    s_add_u32 s9, s9, 8192
    buffer_load_dwordx4 v253, s[92:95], s9 offen lds
Lpw_10_2:
    s_add_u32 m0, s97, 0
    s_add_u32 s9, s96, 0
    buffer_load_dwordx4 v253, s[92:95], s9 offen lds
    s_add_u32 m0, s97, 1024
    s_add_u32 s9, s9, 8192
    buffer_load_dwordx4 v253, s[92:95], s9 offen lds
    s_add_u32 m0, s97, 8192
    s_add_u32 s9, s96, 65536
    buffer_load_dwordx4 v253, s[92:95], s9 offen lds
    s_add_u32 m0, s97, 9216
    s_add_u32 s9, s9, 8192
    buffer_load_dwordx4 v253, s[92:95], s9 offen lds
    s_add_u32 m0, s97, 16384
    s_add_u32 s9, s96, 131072
    buffer_load_dwordx4 v253, s[92:95], s9 offen lds
    s_add_u32 m0, s97, 17408
    s_add_u32 s9, s9, 8192
    buffer_load_dwordx4 v253, s[92:95], s9 offen lds
    s_add_u32 m0, s97, 24576
    s_add_u32 s9, s96, 196608
    buffer_load_dwordx4 v253, s[92:95], s9 offen lds
    s_add_u32 m0, s97, 25600
    s_add_u32 s9, s9, 8192
    buffer_load_dwordx4 v253, s[92:95], s9 offen lds
    s_mul_i32 s9, s11, 5120
    s_add_u32 s9, s9, 143360
    v_add_u32 v13, 62, v1
    v_and_b32 v14, 3, v13
    v_mul_u32_u24 v14, 1280, v14
    v_lshrrev_b32 v13, 2, v13
    v_lshl_add_u32 v14, v13, 4, v14
    v_add_u32 v24, s9, v14
    v_add_u32 v13, 63, v1
    v_and_b32 v14, 3, v13
    v_mul_u32_u24 v14, 1280, v14
    v_lshrrev_b32 v13, 2, v13
    v_lshl_add_u32 v14, v13, 4, v14
    v_add_u32 v25, s9, v14
    v_add_u32 v13, 64, v1
    v_and_b32 v14, 3, v13
    v_mul_u32_u24 v14, 1280, v14
    v_lshrrev_b32 v13, 2, v13
    v_lshl_add_u32 v14, v13, 4, v14
    v_add_u32 v26, s9, v14
    ds_read_b64 v[128:129], v24 offset:8
    ds_read_b128 v[130:133], v25
    ds_read_b64 v[134:135], v26
    s_mul_i32 s9, s11, 4224
    s_add_u32 s9, s9, 82176
    v_lshlrev_b32 v27, 4, v1
    v_add_u32 v27, s9, v27
    s_waitcnt lgkmcnt(0)
    v_lshlrev_b32 v136, 16, v128
    v_and_b32 v137, 0xffff0000, v128
    v_lshlrev_b32 v138, 16, v129
    v_and_b32 v139, 0xffff0000, v129
    v_lshlrev_b32 v140, 16, v130
    v_and_b32 v141, 0xffff0000, v130
    v_lshlrev_b32 v142, 16, v131
    v_and_b32 v143, 0xffff0000, v131
    v_lshlrev_b32 v144, 16, v132
    v_and_b32 v145, 0xffff0000, v132
    v_lshlrev_b32 v146, 16, v133
    v_and_b32 v147, 0xffff0000, v133
    v_lshlrev_b32 v148, 16, v134
    v_and_b32 v149, 0xffff0000, v134
    v_lshlrev_b32 v150, 16, v135
    v_and_b32 v151, 0xffff0000, v135
    v_add_f32 v152, v137, v138
    v_add_f32 v153, v139, v140
    v_add_f32 v154, v141, v142
    v_add_f32 v152, v152, v143
    v_add_f32 v153, v153, v154
    v_add_f32 v152, v152, v153
    v_sub_f32 v161, v144, v137
    v_sub_f32 v162, v145, v138
    v_sub_f32 v163, v146, v139
    v_sub_f32 v164, v147, v140
    v_sub_f32 v165, v148, v141
    v_sub_f32 v166, v149, v142
    v_sub_f32 v167, v150, v143
    v_add_f32 v168, v136, v144
    v_add_f32 v169, v137, v145
    v_add_f32 v170, v138, v146
    v_add_f32 v171, v139, v147
    v_add_f32 v172, v140, v148
    v_add_f32 v173, v141, v149
    v_add_f32 v174, v142, v150
    v_add_f32 v175, v143, v151
    v_add_f32 v153, v152, v161
    v_add_f32 v154, v153, v162
    v_add_f32 v155, v154, v163
    v_add_f32 v156, v155, v164
    v_add_f32 v157, v156, v165
    v_add_f32 v158, v157, v166
    v_add_f32 v159, v158, v167
    v_add_f32 v168, v168, v152
    v_add_f32 v169, v169, v153
    v_add_f32 v170, v170, v154
    v_add_f32 v171, v171, v155
    v_add_f32 v172, v172, v156
    v_add_f32 v173, v173, v157
    v_add_f32 v174, v174, v158
    v_add_f32 v175, v175, v159
    v_cvt_pk_bf16_f32 v176, v152, v153
    v_cvt_pk_bf16_f32 v180, v168, v169
    v_cvt_pk_bf16_f32 v177, v154, v155
    v_cvt_pk_bf16_f32 v181, v170, v171
    v_cvt_pk_bf16_f32 v178, v156, v157
    v_cvt_pk_bf16_f32 v182, v172, v173
    v_cvt_pk_bf16_f32 v179, v158, v159
    v_cvt_pk_bf16_f32 v183, v174, v175
    ds_write_b128 v27, v[176:179] offset:48
    ds_write_b128 v27, v[180:183] offset:2160
    s_add_u32 m0, s97, 32768
    s_add_u32 s9, s96, 128
    buffer_load_dwordx4 v253, s[92:95], s9 offen lds
    s_add_u32 m0, s97, 33792
    s_add_u32 s9, s9, 8192
    buffer_load_dwordx4 v253, s[92:95], s9 offen lds
    s_add_u32 m0, s97, 40960
    s_add_u32 s9, s96, 65664
    buffer_load_dwordx4 v253, s[92:95], s9 offen lds
    s_add_u32 m0, s97, 41984
    s_add_u32 s9, s9, 8192
    buffer_load_dwordx4 v253, s[92:95], s9 offen lds
    s_add_u32 m0, s97, 49152
    s_add_u32 s9, s96, 131200
    buffer_load_dwordx4 v253, s[92:95], s9 offen lds
    s_add_u32 m0, s97, 50176
    s_add_u32 s9, s9, 8192
    buffer_load_dwordx4 v253, s[92:95], s9 offen lds
    s_mul_i32 s9, s11, 5120
    s_add_u32 s9, s9, 143360
    v_add_u32 v13, 126, v1
    v_and_b32 v14, 3, v13
    v_mul_u32_u24 v14, 1280, v14
    v_lshrrev_b32 v13, 2, v13
    v_lshl_add_u32 v14, v13, 4, v14
    v_add_u32 v24, s9, v14
    v_add_u32 v13, 127, v1
    v_and_b32 v14, 3, v13
    v_mul_u32_u24 v14, 1280, v14
    v_lshrrev_b32 v13, 2, v13
    v_lshl_add_u32 v14, v13, 4, v14
    v_add_u32 v25, s9, v14
    v_add_u32 v13, 128, v1
    v_and_b32 v14, 3, v13
    v_mul_u32_u24 v14, 1280, v14
    v_lshrrev_b32 v13, 2, v13
    v_lshl_add_u32 v14, v13, 4, v14
    v_add_u32 v26, s9, v14
    ds_read_b64 v[128:129], v24 offset:8
    ds_read_b128 v[130:133], v25
    ds_read_b64 v[134:135], v26
    s_mul_i32 s9, s11, 4224
    s_add_u32 s9, s9, 82176
    v_lshlrev_b32 v27, 4, v1
    v_add_u32 v27, s9, v27
    s_waitcnt lgkmcnt(0)
    v_lshlrev_b32 v136, 16, v128
    v_and_b32 v137, 0xffff0000, v128
    v_lshlrev_b32 v138, 16, v129
    v_and_b32 v139, 0xffff0000, v129
    v_lshlrev_b32 v140, 16, v130
    v_and_b32 v141, 0xffff0000, v130
    v_lshlrev_b32 v142, 16, v131
    v_and_b32 v143, 0xffff0000, v131
    v_lshlrev_b32 v144, 16, v132
    v_and_b32 v145, 0xffff0000, v132
    v_lshlrev_b32 v146, 16, v133
    v_and_b32 v147, 0xffff0000, v133
    v_lshlrev_b32 v148, 16, v134
    v_and_b32 v149, 0xffff0000, v134
    v_lshlrev_b32 v150, 16, v135
    v_and_b32 v151, 0xffff0000, v135
    v_add_f32 v152, v137, v138
    v_add_f32 v153, v139, v140
    v_add_f32 v154, v141, v142
    v_add_f32 v152, v152, v143
    v_add_f32 v153, v153, v154
    v_add_f32 v152, v152, v153
    v_sub_f32 v161, v144, v137
    v_sub_f32 v162, v145, v138
    v_sub_f32 v163, v146, v139
    v_sub_f32 v164, v147, v140
    v_sub_f32 v165, v148, v141
    v_sub_f32 v166, v149, v142
    v_sub_f32 v167, v150, v143
    v_add_f32 v168, v136, v144
    v_add_f32 v169, v137, v145
    v_add_f32 v170, v138, v146
    v_add_f32 v171, v139, v147
    v_add_f32 v172, v140, v148
    v_add_f32 v173, v141, v149
    v_add_f32 v174, v142, v150
    v_add_f32 v175, v143, v151
    v_add_f32 v153, v152, v161
    v_add_f32 v154, v153, v162
    v_add_f32 v155, v154, v163
    v_add_f32 v156, v155, v164
    v_add_f32 v157, v156, v165
    v_add_f32 v158, v157, v166
    v_add_f32 v159, v158, v167
    v_add_f32 v168, v168, v152
    v_add_f32 v169, v169, v153
    v_add_f32 v170, v170, v154
    v_add_f32 v171, v171, v155
    v_add_f32 v172, v172, v156
    v_add_f32 v173, v173, v157
    v_add_f32 v174, v174, v158
    v_add_f32 v175, v175, v159
    v_cvt_pk_bf16_f32 v176, v152, v153
    v_cvt_pk_bf16_f32 v180, v168, v169
    v_cvt_pk_bf16_f32 v177, v154, v155
    v_cvt_pk_bf16_f32 v181, v170, v171
    v_cvt_pk_bf16_f32 v178, v156, v157
    v_cvt_pk_bf16_f32 v182, v172, v173
    v_cvt_pk_bf16_f32 v179, v158, v159
    v_cvt_pk_bf16_f32 v183, v174, v175
    ds_write_b128 v27, v[176:179] offset:1072
    ds_write_b128 v27, v[180:183] offset:3184
    s_waitcnt vmcnt(6)
    s_add_u32 m0, s97, 57344
    s_add_u32 s9, s96, 196736
    buffer_load_dwordx4 v253, s[92:95], s9 offen lds
    s_add_u32 m0, s97, 58368
    s_add_u32 s9, s9, 8192
    buffer_load_dwordx4 v253, s[92:95], s9 offen lds
    s_add_u32 m0, s97, 65536
    s_add_u32 s9, s96, 262144
    buffer_load_dwordx4 v253, s[92:95], s9 offen lds
    s_add_u32 m0, s97, 66560
    s_add_u32 s9, s9, 8192
    buffer_load_dwordx4 v253, s[92:95], s9 offen lds
    s_add_u32 m0, s97, 73728
    s_add_u32 s9, s96, 327680
    buffer_load_dwordx4 v253, s[92:95], s9 offen lds
    s_add_u32 m0, s97, 74752
    s_add_u32 s9, s9, 8192
    buffer_load_dwordx4 v253, s[92:95], s9 offen lds
    v_mov_b32 v16, 0
    v_mov_b32 v17, 0
    v_mov_b32 v18, 0
    v_mov_b32 v19, 0
    s_mov_b64 exec, 7
    ds_write_b128 v27, v[16:19]
    ds_write_b128 v27, v[16:19] offset:2112
    s_mov_b64 exec, -1
    s_waitcnt vmcnt(25)
    s_mov_b32 s9, 0x01010101
    v_cmp_ne_u32 vcc, s9, v203
    s_cbranch_vccz Lgk_11
    v_and_b32 v20, 7, v1
    v_lshlrev_b32 v20, 2, v20
    s_mov_b32 s10, 0
    s_mov_b32 s9, 0x01010101
Lg_12:
    global_load_dword v21, v20, s[32:33] sc1
    s_add_u32 s10, s10, 1
    s_waitcnt vmcnt(0)
    v_cmp_ne_u32 vcc, s9, v21
    s_cmp_gt_u32 s10, 16384
    s_cbranch_scc1 Lg_13
    s_cbranch_vccz Lg_13
    s_sleep 8
    s_branch Lg_12
Lg_13:
Lgk_11:
    s_waitcnt lgkmcnt(0)
    s_barrier
    s_waitcnt vmcnt(20)
    v_mov_b32 v224, 0
    v_mov_b32 v225, 0
    v_mov_b32 v226, 0
    v_mov_b32 v227, 0
    v_dot2_f32_bf16 v224, v208, v204, v224
    v_dot2_f32_bf16 v225, v212, v204, v225
    v_dot2_f32_bf16 v226, v216, v204, v226
    v_dot2_f32_bf16 v227, v220, v204, v227
    v_dot2_f32_bf16 v224, v209, v205, v224
    v_dot2_f32_bf16 v225, v213, v205, v225
    v_dot2_f32_bf16 v226, v217, v205, v226
    v_dot2_f32_bf16 v227, v221, v205, v227
    v_dot2_f32_bf16 v224, v210, v206, v224
    v_dot2_f32_bf16 v225, v214, v206, v225
    v_dot2_f32_bf16 v226, v218, v206, v226
    v_dot2_f32_bf16 v227, v222, v206, v227
    v_dot2_f32_bf16 v224, v211, v207, v224
    v_dot2_f32_bf16 v225, v215, v207, v225
    v_dot2_f32_bf16 v226, v219, v207, v226
    v_dot2_f32_bf16 v227, v223, v207, v227
    v_add_f32_dpp v224, v224, v224 row_shr:1 row_mask:0xf bank_mask:0xf bound_ctrl:0
    v_add_f32_dpp v225, v225, v225 row_shr:1 row_mask:0xf bank_mask:0xf bound_ctrl:0
    v_add_f32_dpp v226, v226, v226 row_shr:1 row_mask:0xf bank_mask:0xf bound_ctrl:0
    v_add_f32_dpp v227, v227, v227 row_shr:1 row_mask:0xf bank_mask:0xf bound_ctrl:0
    v_add_f32_dpp v224, v224, v224 row_shr:2 row_mask:0xf bank_mask:0xf bound_ctrl:0
    v_add_f32_dpp v225, v225, v225 row_shr:2 row_mask:0xf bank_mask:0xf bound_ctrl:0
    v_add_f32_dpp v226, v226, v226 row_shr:2 row_mask:0xf bank_mask:0xf bound_ctrl:0
    v_add_f32_dpp v227, v227, v227 row_shr:2 row_mask:0xf bank_mask:0xf bound_ctrl:0
    v_add_f32_dpp v224, v224, v224 row_shr:4 row_mask:0xf bank_mask:0xf bound_ctrl:0
    v_add_f32_dpp v225, v225, v225 row_shr:4 row_mask:0xf bank_mask:0xf bound_ctrl:0
    v_add_f32_dpp v226, v226, v226 row_shr:4 row_mask:0xf bank_mask:0xf bound_ctrl:0
    v_add_f32_dpp v227, v227, v227 row_shr:4 row_mask:0xf bank_mask:0xf bound_ctrl:0
    v_add_f32_dpp v224, v224, v224 row_shr:8 row_mask:0xf bank_mask:0xf bound_ctrl:0
    v_add_f32_dpp v225, v225, v225 row_shr:8 row_mask:0xf bank_mask:0xf bound_ctrl:0
    v_add_f32_dpp v226, v226, v226 row_shr:8 row_mask:0xf bank_mask:0xf bound_ctrl:0
    v_add_f32_dpp v227, v227, v227 row_shr:8 row_mask:0xf bank_mask:0xf bound_ctrl:0
    v_add_f32_dpp v224, v224, v224 row_bcast:15 row_mask:0xa bank_mask:0xf
    v_add_f32_dpp v225, v225, v225 row_bcast:15 row_mask:0xa bank_mask:0xf
    v_add_f32_dpp v226, v226, v226 row_bcast:15 row_mask:0xa bank_mask:0xf
    v_add_f32_dpp v227, v227, v227 row_bcast:15 row_mask:0xa bank_mask:0xf
    v_add_f32_dpp v224, v224, v224 row_bcast:31 row_mask:0xc bank_mask:0xf
    v_add_f32_dpp v225, v225, v225 row_bcast:31 row_mask:0xc bank_mask:0xf
    v_add_f32_dpp v226, v226, v226 row_bcast:31 row_mask:0xc bank_mask:0xf
    v_add_f32_dpp v227, v227, v227 row_bcast:31 row_mask:0xc bank_mask:0xf
    v_mul_f32 v224, 0xbfb8aa3b, v224
    v_mul_f32 v225, 0xbfb8aa3b, v225
    v_mul_f32 v226, 0xbfb8aa3b, v226
    v_mul_f32 v227, 0xbfb8aa3b, v227
    v_exp_f32 v224, v224
    v_exp_f32 v225, v225
    v_exp_f32 v226, v226
    v_exp_f32 v227, v227
    v_add_f32 v224, 1.0, v224
    v_add_f32 v225, 1.0, v225
    v_add_f32 v226, 1.0, v226
    v_add_f32 v227, 1.0, v227
    v_rcp_f32 v224, v224
    v_rcp_f32 v225, v225
    v_rcp_f32 v226, v226
    v_rcp_f32 v227, v227
    v_or_b32 v224, 1, v224
    v_or_b32 v225, 1, v225
    v_or_b32 v226, 1, v226
    v_or_b32 v227, 1, v227
    s_lshr_b32 s9, s47, 2
    s_mul_i32 s9, s9, 3840
    s_lshr_b32 s10, s48, 8
    s_and_b32 s10, s10, 0xf0
    s_add_u32 s9, s9, s10
    s_add_u32 s9, s9, 4262400
    v_mov_b32 v20, s9
    s_mov_b32 exec_lo, 0
    s_mov_b32 exec_hi, 0x80000000
    global_store_dwordx4 v20, v[224:227], s[34:35] sc1
    s_mov_b64 exec, -1
    v_add_u32 v238, 0x10000, v238
    s_call_b64 s[100:101], L_setup
    s_nop 0
    s_barrier
    s_add_u32 m0, s97, 81920
    s_add_u32 s9, s96, 393216
    buffer_load_dwordx4 v253, s[92:95], s9 offen lds
    s_add_u32 m0, s97, 82944
    s_add_u32 s9, s9, 8192
    buffer_load_dwordx4 v253, s[92:95], s9 offen lds
    s_add_u32 m0, s97, 90112
    s_add_u32 s9, s96, 458752
    buffer_load_dwordx4 v253, s[92:95], s9 offen lds
    s_add_u32 m0, s97, 91136
    s_add_u32 s9, s9, 8192
    buffer_load_dwordx4 v253, s[92:95], s9 offen lds
    s_add_u32 m0, s97, 98304
    s_add_u32 s9, s96, 262272
    buffer_load_dwordx4 v253, s[92:95], s9 offen lds
    s_add_u32 m0, s97, 99328
    s_add_u32 s9, s9, 8192
    buffer_load_dwordx4 v253, s[92:95], s9 offen lds
    s_add_u32 m0, s97, 106496
    s_add_u32 s9, s96, 327808
    buffer_load_dwordx4 v253, s[92:95], s9 offen lds
    s_add_u32 m0, s97, 107520
    s_add_u32 s9, s9, 8192
    buffer_load_dwordx4 v253, s[92:95], s9 offen lds
    s_add_u32 m0, s97, 114688
    s_add_u32 s9, s96, 393344
    buffer_load_dwordx4 v253, s[92:95], s9 offen lds
    s_add_u32 m0, s97, 115712
    s_add_u32 s9, s9, 8192
    buffer_load_dwordx4 v253, s[92:95], s9 offen lds
    s_add_u32 m0, s97, 122880
    s_add_u32 s9, s96, 458880
    buffer_load_dwordx4 v253, s[92:95], s9 offen lds
    s_add_u32 m0, s97, 123904
    s_add_u32 s9, s9, 8192
    buffer_load_dwordx4 v253, s[92:95], s9 offen lds
    s_branch L_p2w
L_setup:
    v_lshlrev_b32 v3, 4, v1
    s_and_b32 s47, s44, 3
    s_lshr_b32 s48, s44, 2
    v_lshrrev_b32 v12, 5, v1
    v_and_b32 v11, 31, v1
    s_mul_i32 s9, s44, 15360
    s_add_u32 s9, s9, 4259840
    v_add_u32 v4, s9, v3
    v_add_u32 v2, 7680, v4
    v_bfe_u32 v13, v1, 2, 2
    v_mul_u32_u24 v7, 3840, v13
    v_and_b32 v14, 3, v1
    v_lshl_add_u32 v7, v14, 4, v7
    v_add_u32 v7, s9, v7
    v_mul_u32_u24 v8, 576, v13
    v_lshl_add_u32 v8, v14, 3, v8
    s_lshl_b32 s50, s44, 12
    s_add_u32 s50, s50, 131072
    v_add_u32 v8, s50, v8
    v_lshlrev_b32 v17, 3, v1
    v_add_u32 v17, s50, v17
    v_min_u32 v13, 16, v11
    v_lshlrev_b32 v13, 5, v13
    v_lshl_add_u32 v13, v12, 4, v13
    v_add_u32 v18, s50, v13
    v_max_u32 v13, 15, v11
    v_subrev_u32 v13, 15, v13
    v_lshlrev_b32 v13, 5, v13
    v_lshl_add_u32 v13, v12, 4, v13
    v_add_u32 v19, s50, v13
    v_lshrrev_b32 v13, 4, v1
    v_mul_u32_u24 v13, 3840, v13
    v_bfe_u32 v14, v1, 2, 2
    v_lshl_add_u32 v13, v14, 7, v13
    v_and_b32 v14, 3, v1
    v_lshl_add_u32 v13, v14, 2, v13
    v_add_u32 v13, s9, v13
    v_add_u32 v9, 3328, v13
    s_lshr_b32 s9, s62, 1
    s_mul_i32 s9, s9, 3840
    s_lshl_b32 s10, s44, 7
    s_add_u32 s9, s9, s10
    s_add_u32 s9, s9, 4261376
    v_and_b32 v14, 1, v1
    v_lshlrev_b32 v14, 2, v14
    v_add_u32 v10, s9, v14
    s_lshl_b32 s9, s63, 3
    s_lshl_b32 s10, s47, 1
    s_add_u32 s9, s9, s10
    s_add_u32 s9, s9, s48
    s_mul_i32 s9, s9, 3840
    s_add_u32 s9, s9, 4262656
    v_bfe_u32 v13, v1, 2, 2
    v_lshlrev_b32 v13, 7, v13
    v_and_b32 v14, 3, v1
    v_lshl_add_u32 v13, v14, 2, v13
    v_add_u32 v105, s9, v13
    s_lshl_b32 s9, s62, 5
    s_lshl_b32 s10, s44, 2
    s_add_u32 s9, s9, s10
    s_lshl_b32 s9, s9, 10
    s_add_u32 s9, s9, 4096
    v_add_u32 v5, s9, v3
    s_lshl_b32 s9, s63, 7
    s_lshl_b32 s10, s47, 5
    s_add_u32 s9, s9, s10
    s_lshl_b32 s10, s48, 4
    s_add_u32 s9, s9, s10
    s_lshl_b32 s9, s9, 12
    s_lshl_b32 s10, s62, 6
    s_add_u32 s9, s9, s10
    s_add_u32 s49, s9, 2105344
    v_lshlrev_b32 v13, 14, v12
    v_lshl_add_u32 v6, v11, 1, v13
    s_lshr_b32 s9, s62, 1
    s_mul_i32 s9, s9, 3840
    s_and_b32 s10, s62, 1
    s_lshl_b32 s10, s10, 7
    s_add_u32 s9, s9, s10
    s_add_u32 s9, s9, 4262400
    v_lshlrev_b32 v13, 2, v11
    v_add_u32 v15, s9, v13
    s_lshl_b32 s9, s62, 15
    s_lshl_b32 s10, s63, 8
    s_add_u32 s9, s9, s10
    s_lshl_b32 s10, s47, 6
    s_add_u32 s9, s9, s10
    s_lshl_b32 s10, s48, 5
    s_add_u32 s9, s9, s10
    v_lshlrev_b32 v13, 10, v11
    v_lshl_add_u32 v13, v12, 4, v13
    v_add_u32 v16, s9, v13
    s_lshl_b32 s9, s44, 12
    s_add_u32 s9, s9, 131072
    v_add_u32 v13, s9, v3
    s_lshl_b32 s9, s48, 14
    s_add_u32 s9, s9, 131072
    v_add_u32 v14, s9, v3
    s_mov_b32 s54, 0x358637bd
    s_mov_b32 s36, s34
    s_and_b32 s37, s35, 0xffff
    s_mov_b32 s38, 6291456
    s_mov_b32 s39, 0x00020000
    s_setpc_b64 s[100:101]
L_p2w:
    s_waitcnt vmcnt(0)
L_p2:
    s_barrier
    global_load_dword v21, v9, s[34:35] sc1
    global_load_dword v20, v10, s[34:35] sc1
    ds_read_b64_tr_b16 v[128:129], v238 offset:0
    ds_read_b64_tr_b16 v[130:131], v238 offset:1024
    ds_read_b64_tr_b16 v[132:133], v238 offset:2048
    ds_read_b64_tr_b16 v[134:135], v238 offset:3072
    ds_read_b64_tr_b16 v[136:137], v238 offset:4096
    ds_read_b64_tr_b16 v[138:139], v238 offset:5120
    ds_read_b64_tr_b16 v[140:141], v238 offset:6144
    ds_read_b64_tr_b16 v[142:143], v238 offset:7168
    ds_read_b64_tr_b16 v[144:145], v238 offset:8192
    ds_read_b64_tr_b16 v[146:147], v238 offset:9216
    ds_read_b64_tr_b16 v[148:149], v238 offset:10240
    ds_read_b64_tr_b16 v[150:151], v238 offset:11264
    ds_read_b64_tr_b16 v[152:153], v238 offset:12288
    ds_read_b64_tr_b16 v[154:155], v238 offset:13312
    ds_read_b64_tr_b16 v[156:157], v238 offset:14336
    ds_read_b64_tr_b16 v[158:159], v238 offset:15360
    ds_read_b64_tr_b16 v[160:161], v238 offset:16384
    ds_read_b64_tr_b16 v[162:163], v238 offset:17408
    ds_read_b64_tr_b16 v[164:165], v238 offset:18432
    ds_read_b64_tr_b16 v[166:167], v238 offset:19456
    ds_read_b64_tr_b16 v[168:169], v238 offset:20480
    ds_read_b64_tr_b16 v[170:171], v238 offset:21504
    ds_read_b64_tr_b16 v[172:173], v238 offset:22528
    ds_read_b64_tr_b16 v[174:175], v238 offset:23552
    ds_read_b64_tr_b16 v[176:177], v238 offset:24576
    ds_read_b64_tr_b16 v[178:179], v238 offset:25600
    ds_read_b64_tr_b16 v[180:181], v238 offset:26624
    ds_read_b64_tr_b16 v[182:183], v238 offset:27648
    ds_read_b64_tr_b16 v[184:185], v238 offset:28672
    ds_read_b64_tr_b16 v[186:187], v238 offset:29696
    ds_read_b64_tr_b16 v[188:189], v238 offset:30720
    ds_read_b64_tr_b16 v[190:191], v238 offset:31744
    s_mov_b32 s10, 0
    s_mov_b32 s55, 3
Lpp_14:
    s_waitcnt vmcnt(0)
    s_add_u32 s10, s10, 1
    s_cmp_gt_u32 s10, 16384
    s_cselect_b64 s[58:59], 0, -1
    s_bitcmp0_b32 s55, 1
    s_cbranch_scc1 Lp1_16
    v_cmp_ne_u32 vcc, 1, v21
    s_nop 0
    s_and_b64 vcc, vcc, s[58:59]
    s_cbranch_scc1 Lp1_16
    s_and_b32 s55, s55, 1
    s_mov_b32 s57, s55
    global_load_dwordx4 v[32:35], v4, s[34:35] sc1
    global_load_dwordx4 v[36:39], v4, s[34:35] offset:3840 sc1
    global_load_dwordx4 v[40:43], v2, s[34:35] sc1
    global_load_dwordx4 v[44:47], v2, s[34:35] offset:3840 sc1
    global_load_dwordx4 v[48:51], v7, s[34:35] offset:1024 sc1
Lp1_16:
    s_bitcmp0_b32 s55, 0
    s_cbranch_scc1 Lp2_17
    v_cmp_ne_u32 vcc, 1, v20
    s_nop 0
    s_and_b64 vcc, vcc, s[58:59]
    s_cbranch_scc1 Lp2_17
    s_and_b32 s55, s55, 2
    global_load_dwordx4 v[80:83], v5, s[34:35] offset:0 sc1
    global_load_dwordx4 v[84:87], v5, s[34:35] offset:1024 sc1
    global_load_dwordx4 v[88:91], v5, s[34:35] offset:2048 sc1
    global_load_dwordx4 v[92:95], v5, s[34:35] offset:3072 sc1
Lp2_17:
    s_cmp_eq_u32 s55, 0
    s_cbranch_scc1 Lpq_15
    s_sleep 4
    s_bitcmp0_b32 s55, 1
    s_cbranch_scc1 Lp2_17b
    v_cmp_ne_u32 vcc, 1, v21
    s_nop 0
    s_mov_b64 exec, vcc
    global_load_dword v21, v9, s[34:35] sc1
    s_mov_b64 exec, -1
Lp2_17b:
    s_bitcmp0_b32 s55, 0
    s_cbranch_scc1 Lpp_14
    global_load_dword v20, v10, s[34:35] sc1
    s_branch Lpp_14
Lpq_15:
    global_load_dword v106, v105, s[34:35] sc1
    global_load_dword v104, v15, s[34:35] sc1
    s_waitcnt vmcnt(6)
    s_cmp_eq_u32 s57, 1
    s_cbranch_scc1 Lfw_18
    s_waitcnt vmcnt(2)
Lfw_18:
    v_cvt_pk_bf16_f32 v52, v32, v33
    v_cvt_pk_bf16_f32 v53, v34, v35
    ds_write_b64 v17, v[52:53] offset:0
    v_cvt_pk_bf16_f32 v54, v36, v37
    v_cvt_pk_bf16_f32 v55, v38, v39
    ds_write_b64 v17, v[54:55] offset:576
    v_cvt_pk_bf16_f32 v56, v40, v41
    v_cvt_pk_bf16_f32 v57, v42, v43
    ds_write_b64 v17, v[56:57] offset:1152
    v_cvt_pk_bf16_f32 v58, v44, v45
    v_cvt_pk_bf16_f32 v59, v46, v47
    ds_write_b64 v17, v[58:59] offset:1728
    v_cvt_pk_bf16_f32 v60, v48, v49
    v_cvt_pk_bf16_f32 v61, v50, v51
    ds_write_b64 v8, v[60:61] offset:512
    s_waitcnt lgkmcnt(0)
    ds_read_b128 v[64:67], v18 offset:0
    ds_read_b128 v[68:71], v19 offset:576
    ds_read_b128 v[72:75], v18 offset:1152
    ds_read_b128 v[76:79], v19 offset:1728
    s_waitcnt vmcnt(5) lgkmcnt(3)
    v_mfma_f32_32x32x16_bf16 v[192:207], v[64:67], v[80:83], 0
    s_waitcnt vmcnt(4) lgkmcnt(2)
    v_mfma_f32_32x32x16_bf16 v[208:223], v[68:71], v[84:87], 0
    s_waitcnt vmcnt(3) lgkmcnt(1)
    v_mfma_f32_32x32x16_bf16 v[224:239], v[72:75], v[88:91], 0
    s_waitcnt vmcnt(2) lgkmcnt(0)
    v_mfma_f32_32x32x16_bf16 v[240:255], v[76:79], v[92:95], 0
    s_nop 5
    v_add_f32 v200, s54, v200
    v_rcp_f32 v200, v200
    s_nop 0
    v_mul_f32 v192, v200, v192
    v_mul_f32 v193, v200, v193
    v_mul_f32 v194, v200, v194
    v_mul_f32 v195, v200, v195
    v_mul_f32 v196, v200, v196
    v_mul_f32 v197, v200, v197
    v_mul_f32 v198, v200, v198
    v_mul_f32 v199, v200, v199
    v_cvt_pk_bf16_f32 v204, v192, v193
    v_cvt_pk_bf16_f32 v205, v194, v195
    v_cvt_pk_bf16_f32 v206, v196, v197
    v_cvt_pk_bf16_f32 v207, v198, v199
    ds_write_b128 v13, v[204:207] offset:0
    v_add_f32 v208, s54, v208
    v_rcp_f32 v208, v208
    s_nop 0
    v_mul_f32 v216, v208, v216
    v_mul_f32 v217, v208, v217
    v_mul_f32 v218, v208, v218
    v_mul_f32 v219, v208, v219
    v_mul_f32 v220, v208, v220
    v_mul_f32 v221, v208, v221
    v_mul_f32 v222, v208, v222
    v_mul_f32 v223, v208, v223
    v_cvt_pk_bf16_f32 v212, v216, v217
    v_cvt_pk_bf16_f32 v213, v218, v219
    v_cvt_pk_bf16_f32 v214, v220, v221
    v_cvt_pk_bf16_f32 v215, v222, v223
    ds_write_b128 v13, v[212:215] offset:1024
    v_add_f32 v232, s54, v232
    v_rcp_f32 v232, v232
    s_nop 0
    v_mul_f32 v224, v232, v224
    v_mul_f32 v225, v232, v225
    v_mul_f32 v226, v232, v226
    v_mul_f32 v227, v232, v227
    v_mul_f32 v228, v232, v228
    v_mul_f32 v229, v232, v229
    v_mul_f32 v230, v232, v230
    v_mul_f32 v231, v232, v231
    v_cvt_pk_bf16_f32 v236, v224, v225
    v_cvt_pk_bf16_f32 v237, v226, v227
    v_cvt_pk_bf16_f32 v238, v228, v229
    v_cvt_pk_bf16_f32 v239, v230, v231
    ds_write_b128 v13, v[236:239] offset:2048
    v_add_f32 v240, s54, v240
    v_rcp_f32 v240, v240
    s_nop 0
    v_mul_f32 v248, v240, v248
    v_mul_f32 v249, v240, v249
    v_mul_f32 v250, v240, v250
    v_mul_f32 v251, v240, v251
    v_mul_f32 v252, v240, v252
    v_mul_f32 v253, v240, v253
    v_mul_f32 v254, v240, v254
    v_mul_f32 v255, v240, v255
    v_cvt_pk_bf16_f32 v244, v248, v249
    v_cvt_pk_bf16_f32 v245, v250, v251
    v_cvt_pk_bf16_f32 v246, v252, v253
    v_cvt_pk_bf16_f32 v247, v254, v255
    ds_write_b128 v13, v[244:247] offset:3072
    s_waitcnt lgkmcnt(0)
    s_barrier
    ds_read_b128 v[192:195], v14 offset:0
    ds_read_b128 v[196:199], v14 offset:1024
    ds_read_b128 v[200:203], v14 offset:2048
    ds_read_b128 v[204:207], v14 offset:3072
    ds_read_b128 v[208:211], v14 offset:4096
    ds_read_b128 v[212:215], v14 offset:5120
    ds_read_b128 v[216:219], v14 offset:6144
    ds_read_b128 v[220:223], v14 offset:7168
    s_waitcnt lgkmcnt(7)
    v_mfma_f32_32x32x16_bf16 v[32:47], v[128:131], v[192:195], 0
    ds_read_b128 v[224:227], v14 offset:8192
    s_waitcnt lgkmcnt(7)
    v_mfma_f32_32x32x16_bf16 v[32:47], v[132:135], v[196:199], v[32:47]
    ds_read_b128 v[228:231], v14 offset:9216
    s_waitcnt lgkmcnt(7)
    v_mfma_f32_32x32x16_bf16 v[32:47], v[136:139], v[200:203], v[32:47]
    ds_read_b128 v[232:235], v14 offset:10240
    s_waitcnt lgkmcnt(7)
    v_mfma_f32_32x32x16_bf16 v[32:47], v[140:143], v[204:207], v[32:47]
    ds_read_b128 v[236:239], v14 offset:11264
    s_waitcnt lgkmcnt(7)
    v_mfma_f32_32x32x16_bf16 v[32:47], v[144:147], v[208:211], v[32:47]
    ds_read_b128 v[240:243], v14 offset:12288
    s_waitcnt lgkmcnt(7)
    v_mfma_f32_32x32x16_bf16 v[32:47], v[148:151], v[212:215], v[32:47]
    ds_read_b128 v[244:247], v14 offset:13312
    s_waitcnt lgkmcnt(7)
    v_mfma_f32_32x32x16_bf16 v[32:47], v[152:155], v[216:219], v[32:47]
    ds_read_b128 v[248:251], v14 offset:14336
    s_mov_b32 s10, 0
    s_waitcnt vmcnt(0)
Lb_19:
    v_min_u32 v20, v104, v106
    v_cmp_eq_u32 vcc, 0, v20
    s_add_u32 s10, s10, 1
    s_cmp_gt_u32 s10, 16384
    s_cbranch_scc1 Lb_20
    s_cbranch_vccz Lb_20
    s_sleep 4
    global_load_dword v106, v105, s[34:35] sc1
    global_load_dword v104, v15, s[34:35] sc1
    s_waitcnt vmcnt(0)
    s_branch Lb_19
Lb_20:
    s_add_u32 s9, s49, 0
    buffer_load_ushort v96, v6, s[36:39], s9 offen sc1
    s_add_u32 s9, s49, 4096
    buffer_load_ushort v97, v6, s[36:39], s9 offen sc1
    s_add_u32 s9, s49, 8192
    buffer_load_ushort v98, v6, s[36:39], s9 offen sc1
    s_add_u32 s9, s49, 12288
    buffer_load_ushort v99, v6, s[36:39], s9 offen sc1
    s_add_u32 s9, s49, 32768
    buffer_load_ushort v100, v6, s[36:39], s9 offen sc1
    s_add_u32 s9, s49, 36864
    buffer_load_ushort v101, v6, s[36:39], s9 offen sc1
    s_add_u32 s9, s49, 40960
    buffer_load_ushort v102, v6, s[36:39], s9 offen sc1
    s_add_u32 s9, s49, 45056
    buffer_load_ushort v103, v6, s[36:39], s9 offen sc1
    s_waitcnt lgkmcnt(7)
    v_mfma_f32_32x32x16_bf16 v[32:47], v[156:159], v[220:223], v[32:47]
    ds_read_b128 v[252:255], v14 offset:15360
    s_waitcnt lgkmcnt(7)
    v_mfma_f32_32x32x16_bf16 v[32:47], v[160:163], v[224:227], v[32:47]
    s_waitcnt lgkmcnt(6)
    v_mfma_f32_32x32x16_bf16 v[32:47], v[164:167], v[228:231], v[32:47]
    s_waitcnt lgkmcnt(5)
    v_mfma_f32_32x32x16_bf16 v[32:47], v[168:171], v[232:235], v[32:47]
    s_waitcnt lgkmcnt(4)
    v_mfma_f32_32x32x16_bf16 v[32:47], v[172:175], v[236:239], v[32:47]
    s_waitcnt lgkmcnt(3)
    v_mfma_f32_32x32x16_bf16 v[32:47], v[176:179], v[240:243], v[32:47]
    s_waitcnt lgkmcnt(2)
    v_mfma_f32_32x32x16_bf16 v[32:47], v[180:183], v[244:247], v[32:47]
    s_waitcnt lgkmcnt(1)
    v_mfma_f32_32x32x16_bf16 v[32:47], v[184:187], v[248:251], v[32:47]
    s_waitcnt lgkmcnt(0)
    v_mfma_f32_32x32x16_bf16 v[32:47], v[188:191], v[252:255], v[32:47]
    s_lshl_b32 s9, s44, 11
    v_add_u32 v13, s9, v3
    s_xor_b32 s9, s9, 8192
    v_add_u32 v14, s9, v3
    s_waitcnt vmcnt(0)
    v_lshlrev_b32 v72, 16, v96
    v_lshlrev_b32 v73, 16, v97
    v_lshlrev_b32 v74, 16, v98
    v_lshlrev_b32 v75, 16, v99
    v_lshlrev_b32 v76, 16, v100
    v_lshlrev_b32 v77, 16, v101
    v_lshlrev_b32 v78, 16, v102
    v_lshlrev_b32 v79, 16, v103
    s_cmp_eq_u32 s48, 0
    s_cbranch_scc1 Le_21
    ds_write_b128 v13, v[32:35]
    ds_write_b128 v13, v[36:39] offset:1024
    v_mov_b32 v32, v40
    v_mov_b32 v33, v41
    v_mov_b32 v34, v42
    v_mov_b32 v35, v43
    v_mov_b32 v36, v44
    v_mov_b32 v37, v45
    v_mov_b32 v38, v46
    v_mov_b32 v39, v47
    s_branch Le_22
Le_21:
    ds_write_b128 v13, v[40:43]
    ds_write_b128 v13, v[44:47] offset:1024
Le_22:
    v_sub_f32 v32, v32, v72
    v_sub_f32 v33, v33, v73
    v_sub_f32 v34, v34, v74
    v_sub_f32 v35, v35, v75
    v_sub_f32 v36, v36, v76
    v_sub_f32 v37, v37, v77
    v_sub_f32 v38, v38, v78
    v_sub_f32 v39, v39, v79
    s_waitcnt lgkmcnt(0)
    s_barrier
    ds_read_b128 v[64:67], v14
    ds_read_b128 v[68:71], v14 offset:1024
    s_waitcnt lgkmcnt(0)
    v_add_f32 v32, v32, v64
    v_add_f32 v33, v33, v65
    v_add_f32 v34, v34, v66
    v_add_f32 v35, v35, v67
    v_add_f32 v36, v36, v68
    v_add_f32 v37, v37, v69
    v_add_f32 v38, v38, v70
    v_add_f32 v39, v39, v71
    v_fmac_f32 v72, v104, v32
    v_fmac_f32 v73, v104, v33
    v_fmac_f32 v74, v104, v34
    v_fmac_f32 v75, v104, v35
    v_fmac_f32 v76, v104, v36
    v_fmac_f32 v77, v104, v37
    v_fmac_f32 v78, v104, v38
    v_fmac_f32 v79, v104, v39
    v_cvt_pk_bf16_f32 v80, v72, v73
    v_cvt_pk_bf16_f32 v81, v74, v75
    v_cvt_pk_bf16_f32 v82, v76, v77
    v_cvt_pk_bf16_f32 v83, v78, v79
    s_nop 0
    v_permlane32_swap_b32 v80, v82
    v_permlane32_swap_b32 v81, v83
    global_store_dwordx4 v16, v[80:83], s[30:31]
L_end:
    s_endpgm
CODE_END:
.section .rodata,"a"

.p2align 6
.amdhsa_kernel gated_mix__linear_attn_block__ssm_conv_s4d__prompt_kernel
  .amdhsa_next_free_vgpr 256
  .amdhsa_next_free_sgpr 102
  .amdhsa_accum_offset 256
  .amdhsa_group_segment_fixed_size 0
  .amdhsa_kernarg_size 112
  .amdhsa_user_sgpr_count 2
  .amdhsa_user_sgpr_kernarg_segment_ptr 1
  .amdhsa_system_sgpr_workgroup_id_x 1
  .amdhsa_float_denorm_mode_32 3
.end_amdhsa_kernel
```
